```python
import torch

def _softmax(x, axis=-1):
    return torch.softmax(x, dim=axis)
def _gelu(x):
    return torch.nn.functional.gelu(x, approximate="tanh")
def _silu(x):
    return torch.nn.functional.silu(x)
def _sigmoid(x):
    return torch.sigmoid(x)
def _layernorm(x, axis=-1, eps=1e-5):
    m = x.mean(dim=axis, keepdim=True)
    v = x.var(dim=axis, keepdim=True, unbiased=False)
    return (x - m) / torch.sqrt(v + eps)
def _scatter_add(tgt, idx, src, axis=0):
    return tgt.clone().index_add_(axis, idx, src)
def _segment_sum(src, seg, n):
    out = torch.zeros((n,) + src.shape[1:], dtype=src.dtype)
    return out.index_add_(0, seg, src)
def _pad(x, pw):
    flat = tuple(v for pair in reversed(pw) for v in pair)
    return torch.nn.functional.pad(x, flat)

kernel_name = 'concat_heads__linear_attn_block__grouped_kv_mqa__prompt'

def setup_inputs():

    _w = (lambda a: (lambda t: t.to(torch.bfloat16) if t.is_floating_point() else t)(torch.as_tensor(a)))
    def _A_setup():
        B, S, D = 1, 2048, 1024
        return {
            "x": _w((lambda *s: torch.randn(*s, dtype=torch.bfloat16) * 0.05)(B, S, D)),
            "wqkv": _w((lambda *s: torch.randn(*s, dtype=torch.bfloat16) * 0.8)(D, 3 * D)),
            "wo": _w((lambda *s: torch.randn(*s, dtype=torch.bfloat16) * 0.05)(D, D)),
        }
    _A_in = _A_setup()

    def _B_setup():
        B, S, D, H = 1, 2048, 1024, 32
        Dh = D // H
        return {
            "x": _w((lambda *s: torch.randn(*s, dtype=torch.bfloat16) * 0.05)(B, S, D)),
            "wq": _w((lambda *s: torch.randn(*s, dtype=torch.bfloat16) * 0.8)(D, H * Dh)),
            "wk": _w((lambda *s: torch.randn(*s, dtype=torch.bfloat16) * 0.8)(D, Dh)),
            "wv": _w((lambda *s: torch.randn(*s, dtype=torch.bfloat16) * 0.05)(D, Dh)),
            "wo": _w((lambda *s: torch.randn(*s, dtype=torch.bfloat16) * 0.05)(H * Dh, D)),
        }
    _B_in = _B_setup()

    return {
        "A_x": _A_in["x"],
        "A_wqkv": _A_in["wqkv"],
        "A_wo": _A_in["wo"],
        "B_x": _B_in["x"],
        "B_wq": _B_in["wq"],
        "B_wk": _B_in["wk"],
        "B_wv": _B_in["wv"],
        "B_wo": _B_in["wo"],
    }

def reference(A_x, A_wqkv, A_wo, B_x, B_wq, B_wk, B_wv, B_wo):
    def _A_ref(x, wqkv, wo):
        B, S, D = x.shape
        H = 32; Dh = D // H
        qkv = (lambda x, *d: x.permute(*d))((x @ wqkv).reshape(B, S, 3, H, Dh), 2, 0, 3, 1, 4)
        q, k, v = qkv[0], qkv[1], qkv[2]
        phi = lambda t: torch.where(t > 0, t + 1, torch.exp(t)) + 1e-6
        pq, pk = phi(q), phi(k)
        kv = torch.einsum("bhsd,bhse->bhde", pk, v)
        z = torch.einsum("bhsd->bhd", pk)
        num = torch.einsum("bhqd,bhde->bhqe", pq, kv)
        den = torch.einsum("bhqd,bhd->bhq", pq, z)[..., None] + 1e-6
        o = num / den
        return (lambda x, *d: x.permute(*d))(o, 0, 2, 1, 3).reshape(B, S, D) @ wo

    def _B_ref(x, wq, wk, wv, wo):
        B, S, D = x.shape
        H = 32
        Dh = D // H
        q = (lambda x, *d: x.permute(*d))((x @ wq).reshape(B, S, H, Dh), 0, 2, 1, 3)
        k = x @ wk
        v = x @ wv
        scores = torch.einsum("bhqd,bkd->bhqk", q, k) * (Dh ** -0.5)
        p = _softmax(scores, axis=-1)
        o = torch.einsum("bhqk,bkd->bhqd", p, v)
        return (lambda x, *d: x.permute(*d))(o, 0, 2, 1, 3).reshape(B, S, H * Dh) @ wo

    a = _A_ref(A_x, A_wqkv, A_wo)
    b = _B_ref(B_x, B_wq, B_wk, B_wv, B_wo)
    return torch.concatenate([a, b], axis=-1)
```

```asm
; @launch grid=(256,1,1) block=(512,1,1) lds=163840
.amdgcn_target "amdgcn-amd-amdhsa--gfx950"
.text
.globl concat_heads__linear_attn_block__grouped_kv_mqa__prompt_kernel
.p2align 8
.type concat_heads__linear_attn_block__grouped_kv_mqa__prompt_kernel,@function
concat_heads__linear_attn_block__grouped_kv_mqa__prompt_kernel:
    s_cmp_ge_u32 s2, 256
    s_cbranch_scc1 K_END
    s_load_dwordx16 s[40:55], s[0:1], 0
    s_load_dwordx4 s[56:59], s[0:1], 64
    s_load_dwordx2 s[60:61], s[0:1], 80
    v_lshrrev_b32 v1, 6, v0
    v_and_b32 v2, 63, v0
    s_and_b32 s20, s2, 7
    s_lshr_b32 s21, s2, 3
    v_readfirstlane_b32 s22, v1
    s_and_b32 s27, s20, 3
    s_lshr_b32 s26, s20, 2
    s_cmp_lt_u32 s21, 16
    s_cbranch_scc0 K1_MAPY
    s_lshl_b32 s23, s27, 2
    s_and_b32 s25, s21, 3
    s_add_u32 s23, s23, s25
    s_lshl_b32 s24, s26, 2
    s_lshr_b32 s25, s21, 2
    s_add_u32 s24, s24, s25
    s_mov_b32 s28, 0
    s_and_b32 s33, s24, 3
    s_branch K1_MAPD
K1_MAPY:
    s_lshl_b32 s23, s27, 1
    s_and_b32 s25, s21, 1
    s_add_u32 s23, s23, s25
    s_lshl_b32 s24, s26, 3
    s_bfe_u32 s25, s21, 0x30001
    s_add_u32 s24, s24, s25
    s_mov_b32 s28, 1
    s_mov_b32 s33, 0
K1_MAPD:
    s_and_b32 s26, s22, 3
    s_cmp_lt_u32 s22, 4
    s_cbranch_scc1 K1_COMPUTE
    v_lshrrev_b32 v4, 4, v2
    s_lshl_b32 s25, s26, 2
    v_add_u32 v4, s25, v4
    v_and_b32 v4, 7, v4
    v_and_b32 v5, 7, v2
    v_xor_b32 v4, v4, v5
    v_lshlrev_b32 v4, 4, v4
    v_lshrrev_b32 v5, 3, v2
    v_lshl_add_u32 v3, v5, 11, v4
    v_lshrrev_b32 v4, 4, v2
    v_and_b32 v5, 15, v2
    v_lshlrev_b32 v8, 2, v4
    v_xor_b32 v5, v5, v8
    s_and_b32 s25, s26, 2
    v_xor_b32 v5, s25, v5
    s_lshl_b32 s37, s26, 10
    s_mov_b32 s34, s37
    s_mov_b32 s35, 0
    s_cmp_eq_u32 s28, 1
    s_cbranch_scc1 K1_LY
    s_lshl_b32 s27, s23, 4
    s_add_u32 s27, s27, s26
    s_lshl_b32 s27, s27, 14
    s_add_u32 s25, s33, 0
    s_and_b32 s25, s25, 3
    s_lshl_b32 s25, s25, 16
    s_add_u32 s68, s25, s27
    s_add_u32 s25, s33, 1
    s_and_b32 s25, s25, 3
    s_lshl_b32 s25, s25, 16
    s_add_u32 s69, s25, s27
    s_add_u32 s25, s33, 2
    s_and_b32 s25, s25, 3
    s_lshl_b32 s25, s25, 16
    s_add_u32 s70, s25, s27
    s_add_u32 s25, s33, 3
    s_and_b32 s25, s25, 3
    s_lshl_b32 s25, s25, 16
    s_add_u32 s71, s25, s27
    s_lshl_b32 s25, s24, 8
    v_lshl_add_u32 v8, v5, 4, s25
    v_lshl_add_u32 v6, v4, 11, v8
    s_lshl_b32 s76, s26, 13
    s_add_u32 s77, s76, 32768
    s_add_u32 s78, s76, 65536
    s_add_u32 s79, s76, 98304
    v_lshl_add_u32 v7, v2, 4, s37
    v_and_b32 v12, 32, v2
    v_xor_b32 v7, v7, v12
    s_add_u32 s29, s37, 147456
    s_lshr_b32 s38, s21, 2
    s_xor_b32 s38, s38, s21
    s_and_b32 s38, s38, 3
    v_mov_b32 v13, v3
    v_mov_b32 v14, v6
    v_mov_b32 v15, v7
    s_xor_b32 s25, s35, s38
    s_and_b32 s25, s25, 15
    s_lshl_b32 s27, s25, 7
    v_add_u32 v3, s27, v13
    s_mul_i32 s27, s25, 131072
    v_add_u32 v6, s27, v14
    s_lshl_b32 s27, s25, 12
    v_add_u32 v7, s27, v15
    s_waitcnt lgkmcnt(0)
    s_mov_b32 s4, s46
    s_and_b32 s5, s47, 0xffff
    s_mov_b32 s6, 4194304
    s_mov_b32 s7, 0x20000
    s_mov_b32 s8, s48
    s_and_b32 s9, s49, 0xffff
    s_mov_b32 s10, 2097152
    s_mov_b32 s11, 0x20000
    s_bitcmp1_b32 s24, 2
    s_cselect_b64 s[62:63], s[52:53], s[50:51]
    s_mov_b32 s12, s62
    s_and_b32 s13, s63, 0xffff
    s_mov_b32 s14, 65536
    s_mov_b32 s15, 0x20000
    s_branch K1_XINB
K1_XLB:
    s_cmp_lt_u32 s35, 2
    s_cbranch_scc1 K1_XINB
    s_waitcnt vmcnt(9)
    s_barrier
K1_XINB:
    s_add_u32 m0, s34, 0
    s_nop 0
    buffer_load_dwordx4 v3, s[4:7], s68 offen lds
    s_add_u32 m0, s34, 16384
    s_nop 0
    buffer_load_dwordx4 v6, s[8:11], s76 offen lds
    s_add_u32 m0, s34, 32768
    s_nop 0
    buffer_load_dwordx4 v7, s[12:15], 0 offen lds
    s_add_u32 m0, s34, 4096
    s_nop 0
    buffer_load_dwordx4 v3, s[4:7], s69 offen lds
    s_add_u32 m0, s34, 20480
    s_nop 0
    buffer_load_dwordx4 v6, s[8:11], s77 offen lds
    s_add_u32 m0, s34, 8192
    s_nop 0
    buffer_load_dwordx4 v3, s[4:7], s70 offen lds
    s_add_u32 m0, s34, 24576
    s_nop 0
    buffer_load_dwordx4 v6, s[8:11], s78 offen lds
    s_add_u32 m0, s34, 12288
    s_nop 0
    buffer_load_dwordx4 v3, s[4:7], s71 offen lds
    s_add_u32 m0, s34, 28672
    s_nop 0
    buffer_load_dwordx4 v6, s[8:11], s79 offen lds
    s_add_u32 s34, s34, 36864
    s_cmp_ge_u32 s34, s29
    s_cselect_b32 s34, s37, s34
    s_add_u32 s35, s35, 1
    s_xor_b32 s25, s35, s38
    s_and_b32 s25, s25, 15
    s_lshl_b32 s27, s25, 7
    v_add_u32 v3, s27, v13
    s_mul_i32 s27, s25, 131072
    v_add_u32 v6, s27, v14
    s_lshl_b32 s27, s25, 12
    v_add_u32 v7, s27, v15
    s_cmp_lt_u32 s35, 16
    s_cbranch_scc1 K1_XLB
    s_mov_b32 s4, s40
    s_and_b32 s5, s41, 0xffff
    s_mov_b32 s6, 4194304
    s_mov_b32 s7, 0x20000
    s_mov_b32 s8, s42
    s_and_b32 s9, s43, 0xffff
    s_mov_b32 s10, 6291456
    s_mov_b32 s11, 0x20000
    v_mul_u32_u24 v14, 6144, v4
    v_add_u32 v14, v14, v8
    s_xor_b32 s25, s35, s38
    s_and_b32 s25, s25, 15
    s_lshl_b32 s27, s25, 7
    v_add_u32 v3, s27, v13
    s_mul_i32 s27, s25, 393216
    v_add_u32 v9, s27, v14
    s_mul_i32 s76, s26, 24576
    s_add_u32 s77, s76, 98304
    s_add_u32 s78, s76, 196608
    s_add_u32 s79, s76, 294912
K1_XLA:
    s_waitcnt vmcnt(8)
    s_barrier
    s_add_u32 m0, s34, 0
    s_nop 0
    buffer_load_dwordx4 v3, s[4:7], s68 offen lds
    s_add_u32 m0, s34, 16384
    s_nop 0
    buffer_load_dwordx4 v9, s[8:11], s76 offen lds
    s_add_u32 m0, s34, 4096
    s_nop 0
    buffer_load_dwordx4 v3, s[4:7], s69 offen lds
    s_add_u32 m0, s34, 20480
    s_nop 0
    buffer_load_dwordx4 v9, s[8:11], s77 offen lds
    s_add_u32 m0, s34, 8192
    s_nop 0
    buffer_load_dwordx4 v3, s[4:7], s70 offen lds
    s_add_u32 m0, s34, 24576
    s_nop 0
    buffer_load_dwordx4 v9, s[8:11], s78 offen lds
    s_add_u32 m0, s34, 12288
    s_nop 0
    buffer_load_dwordx4 v3, s[4:7], s71 offen lds
    s_add_u32 m0, s34, 28672
    s_nop 0
    buffer_load_dwordx4 v9, s[8:11], s79 offen lds
    s_add_u32 s34, s34, 36864
    s_cmp_ge_u32 s34, s29
    s_cselect_b32 s34, s37, s34
    s_add_u32 s35, s35, 1
    s_xor_b32 s25, s35, s38
    s_and_b32 s25, s25, 15
    s_lshl_b32 s27, s25, 7
    v_add_u32 v3, s27, v13
    s_mul_i32 s27, s25, 393216
    v_add_u32 v9, s27, v14
    s_cmp_lt_u32 s35, 32
    s_cbranch_scc1 K1_XLA
    s_waitcnt vmcnt(8)
    s_branch K1_LTAIL
K1_LY:
    s_lshl_b32 s27, s23, 5
    s_add_u32 s27, s27, s26
    s_lshl_b32 s68, s27, 14
    s_add_u32 s69, s68, 65536
    s_add_u32 s70, s68, 131072
    s_add_u32 s71, s68, 196608
    s_add_u32 s72, s68, 262144
    s_add_u32 s73, s68, 327680
    s_add_u32 s74, s68, 393216
    s_add_u32 s75, s68, 458752
    v_mul_u32_u24 v6, 6144, v4
    v_and_b32 v8, 3, v5
    v_lshl_add_u32 v6, v8, 4, v6
    v_bfe_u32 v8, v5, 2, 1
    v_lshl_add_u32 v6, v8, 11, v6
    v_bfe_u32 v8, v5, 3, 1
    v_lshl_add_u32 v6, v8, 6, v6
    s_lshl_b32 s25, s24, 7
    s_add_u32 s25, s25, 2048
    v_add_u32 v6, s25, v6
    s_mul_i32 s76, s26, 24576
    s_add_u32 s77, s76, 98304
    s_add_u32 s78, s76, 196608
    s_add_u32 s79, s76, 294912
    s_add_u32 s29, s37, 159744
    s_lshr_b32 s89, s21, 1
    s_and_b32 s25, s21, 1
    s_mul_i32 s25, s25, 1
    s_xor_b32 s89, s89, s25
    s_and_b32 s89, s89, 0
    v_mov_b32 v13, v3
    v_mov_b32 v14, v6
    s_xor_b32 s25, s35, s89
    s_lshl_b32 s27, s25, 7
    v_add_u32 v3, s27, v13
    s_mul_i32 s27, s25, 393216
    v_add_u32 v6, s27, v14
    s_waitcnt lgkmcnt(0)
    s_mov_b32 s4, s40
    s_and_b32 s5, s41, 0xffff
    s_mov_b32 s6, 4194304
    s_mov_b32 s7, 0x20000
    s_mov_b32 s8, s42
    s_and_b32 s9, s43, 0xffff
    s_mov_b32 s10, 6291456
    s_mov_b32 s11, 0x20000
    s_branch K1_YIN
K1_YL:
    s_cmp_lt_u32 s35, 2
    s_cbranch_scc1 K1_YIN
    s_waitcnt vmcnt(14)
    s_barrier
K1_YIN:
    s_add_u32 m0, s34, 0
    s_nop 0
    buffer_load_dwordx4 v3, s[4:7], s68 offen lds
    s_add_u32 m0, s34, 32768
    s_nop 0
    buffer_load_dwordx4 v6, s[8:11], s76 offen lds
    s_add_u32 m0, s34, 4096
    s_nop 0
    buffer_load_dwordx4 v3, s[4:7], s69 offen lds
    s_add_u32 m0, s34, 8192
    s_nop 0
    buffer_load_dwordx4 v3, s[4:7], s70 offen lds
    s_add_u32 m0, s34, 36864
    s_nop 0
    buffer_load_dwordx4 v6, s[8:11], s77 offen lds
    s_add_u32 m0, s34, 12288
    s_nop 0
    buffer_load_dwordx4 v3, s[4:7], s71 offen lds
    s_add_u32 m0, s34, 16384
    s_nop 0
    buffer_load_dwordx4 v3, s[4:7], s72 offen lds
    s_add_u32 m0, s34, 40960
    s_nop 0
    buffer_load_dwordx4 v6, s[8:11], s78 offen lds
    s_add_u32 m0, s34, 20480
    s_nop 0
    buffer_load_dwordx4 v3, s[4:7], s73 offen lds
    s_add_u32 m0, s34, 24576
    s_nop 0
    buffer_load_dwordx4 v3, s[4:7], s74 offen lds
    s_add_u32 m0, s34, 45056
    s_nop 0
    buffer_load_dwordx4 v6, s[8:11], s79 offen lds
    s_add_u32 m0, s34, 28672
    s_nop 0
    buffer_load_dwordx4 v3, s[4:7], s75 offen lds
    s_cmp_eq_u32 s35, 0
    s_cbranch_scc0 K1_PFS
    s_bfe_u32 s38, s21, 0x10003
    s_and_b32 s39, s21, 7
    s_lshl_b32 s39, s39, 3
    s_add_u32 s39, s39, s20
    s_cmp_lt_u32 s26, 2
    s_cbranch_scc0 PFW_1
    v_lshrrev_b32 v12, 1, v2
    v_lshlrev_b32 v10, 11, v12
    v_and_b32 v12, 1, v2
    v_lshl_add_u32 v10, v12, 7, v10
    s_lshl_b32 s82, s39, 16
    s_mov_b32 s83, 4194304
    s_mov_b32 s90, 0x3fffff
    s_cmp_eq_u32 s26, 1
    s_cselect_b64 s[62:63], s[46:47], s[40:41]
    s_mov_b32 s30, 4
    s_branch PFD_2
PFW_1:
    v_lshlrev_b32 v10, 7, v2
    s_mov_b32 s90, -1
    s_lshl_b32 s30, s39, 1
    s_add_u32 s30, s30, s26
    s_sub_u32 s30, s30, 2
    s_sub_u32 s31, s30, 96
    s_cmp_lt_u32 s30, 96
    s_cselect_b32 s82, s30, s31
    s_cselect_b64 s[62:63], s[42:43], s[48:49]
    s_cselect_b32 s30, 6, 2
    s_lshl_b32 s83, s30, 17
    s_lshl_b32 s82, s82, 13
PFD_2:
    s_mov_b32 s64, s62
    s_and_b32 s65, s63, 0xffff
    s_lshl_b32 s66, s30, 20
    s_mov_b32 s67, 0x20000
    s_add_u32 s39, s38, 2
    s_mul_i32 s39, s39, s83
    s_add_u32 s82, s82, s39
    s_lshl_b32 s83, s83, 1
    s_cmp_eq_u32 s38, 0
    s_mov_b32 s88, 7
    s_cselect_b32 s88, 7, s88
K1_PFS:
    s_bitcmp1_b32 s88, s35
    s_cbranch_scc0 K1_PFX
    s_andn2_b32 s31, s82, s90
    s_lshr_b32 s31, s31, 14
    s_and_b32 s30, s82, s90
    s_add_u32 s30, s30, s31
    buffer_load_dword v11, v10, s[64:67], s30 offen
    s_add_u32 s82, s82, s83
    s_branch K1_PFY
K1_PFX:
    s_mov_b32 s30, 1073741824
    buffer_load_dword v11, off, s[64:67], s30
K1_PFY:
    s_add_u32 s34, s34, 53248
    s_cmp_ge_u32 s34, s29
    s_cselect_b32 s34, s37, s34
    s_add_u32 s35, s35, 1
    s_xor_b32 s25, s35, s89
    s_lshl_b32 s27, s25, 7
    v_add_u32 v3, s27, v13
    s_mul_i32 s27, s25, 393216
    v_add_u32 v6, s27, v14
    s_cmp_lt_u32 s35, 16
    s_cbranch_scc1 K1_YL
    s_waitcnt vmcnt(14)
K1_LTAIL:
    s_barrier
    s_mov_b32 s16, s60
    s_and_b32 s17, s61, 0xffff
    s_mov_b32 s18, 18259968
    s_mov_b32 s19, 0x20000
    s_mov_b32 s84, s58
    s_and_b32 s85, s59, 0xffff
    s_mov_b32 s86, 256
    s_mov_b32 s87, 0x20000
    v_mov_b32 v119, 0
    v_mov_b32 v120, 1
    s_lshl_b32 s25, s26, 1
    s_add_u32 s25, s25, s28
    s_cmp_eq_u32 s25, 1
    s_cbranch_scc0 K1_NI
    buffer_load_dword v120, v119, s[84:87], 0 offen sc1
K1_NI:
    s_waitcnt vmcnt(0)
    s_mov_b32 s96, 300000
POLL_3:
    v_cmp_gt_u32 vcc, 1, v120
    s_sub_u32 s96, s96, 1
    s_cbranch_vccz POLLD_4
    s_sleep 8
    buffer_load_dword v120, v119, s[84:87], 0 offen sc1
    s_waitcnt vmcnt(0)
    s_cmp_lg_u32 s96, 0
    s_cbranch_scc1 POLL_3
POLLD_4:
    s_barrier
    s_and_b32 s92, s2, 15
    s_lshl_b32 s92, s92, 7
    s_add_u32 s92, s92, 18251776
    s_lshl_b32 s93, s2, 7
    s_add_u32 s93, s93, 18186240
    buffer_load_dword v120, v119, s[16:19], s92 offen sc1
    buffer_load_dword v121, v119, s[16:19], s93 offen offset:4 sc1
    s_barrier
    s_setprio 2
    s_and_b32 s23, s2, 31
    s_lshr_b32 s24, s2, 5
    v_lshlrev_b32 v1, 4, v2
    v_lshrrev_b32 v7, 5, v2
    s_and_b32 s26, s22, 3
    s_lshl_b32 s29, s24, 2
    s_add_u32 s29, s29, s26
    s_mul_i32 s29, s29, 131584
    s_lshl_b32 s25, s23, 11
    s_add_u32 s29, s29, s25
    s_and_b32 s89, s20, 3
    s_lshl_b32 s89, s89, 2
    s_and_b32 s25, s21, 3
    s_add_u32 s89, s89, s25
    s_lshr_b32 s90, s20, 2
    s_lshl_b32 s90, s90, 3
    s_lshr_b32 s25, s21, 2
    s_add_u32 s90, s90, s25
    s_lshl_b32 s91, s89, 4
    s_add_u32 s91, s91, s90
    s_lshl_b32 s91, s91, 7
    s_add_u32 s91, s91, 18219008
    s_lshl_b32 s30, s26, 12
    s_add_u32 s31, s30, 16842752
    s_add_u32 s68, s29, 4210688
    s_add_u32 s69, s68, 63744
    s_waitcnt vmcnt(0)
    s_mov_b32 s96, 300000
POLL_5:
    v_cmp_gt_u32 vcc, 128, v120
    s_sub_u32 s96, s96, 1
    s_cbranch_vccz POLLD_6
    s_sleep 8
    buffer_load_dword v120, v119, s[16:19], s92 offen sc1
    s_waitcnt vmcnt(0)
    s_cmp_lg_u32 s96, 0
    s_cbranch_scc1 POLL_5
POLLD_6:
    s_mov_b32 s96, 300000
POLL_7:
    v_cmp_gt_u32 vcc, 4, v121
    s_sub_u32 s96, s96, 1
    s_cbranch_vccz POLLD_8
    s_sleep 8
    buffer_load_dword v121, v119, s[16:19], s93 offen offset:4 sc1
    s_waitcnt vmcnt(0)
    s_cmp_lg_u32 s96, 0
    s_cbranch_scc1 POLL_7
POLLD_8:
    s_add_u32 m0, s30, 16384
    s_nop 0
    buffer_load_dwordx4 v1, s[16:19], s68 offen offset:0 sc1 lds
    buffer_load_dwordx4 v1, s[16:19], s68 offen offset:1024 sc1 lds
    buffer_load_dwordx4 v1, s[16:19], s69 offen offset:2048 sc1 lds
    buffer_load_dwordx4 v1, s[16:19], s69 offen offset:3072 sc1 lds
    s_add_u32 m0, s30, 81920
    s_nop 0
    buffer_load_dwordx4 v1, s[16:19], s31 offen offset:0 sc1 lds
    buffer_load_dwordx4 v1, s[16:19], s31 offen offset:1024 sc1 lds
    buffer_load_dwordx4 v1, s[16:19], s31 offen offset:2048 sc1 lds
    buffer_load_dwordx4 v1, s[16:19], s31 offen offset:3072 sc1 lds
    s_add_u32 s31, s31, 16384
    s_waitcnt vmcnt(0)
    s_barrier
    s_add_u32 m0, s30, 98304
    s_nop 0
    buffer_load_dwordx4 v1, s[16:19], s31 offen offset:0 sc1 lds
    buffer_load_dwordx4 v1, s[16:19], s31 offen offset:1024 sc1 lds
    buffer_load_dwordx4 v1, s[16:19], s31 offen offset:2048 sc1 lds
    buffer_load_dwordx4 v1, s[16:19], s31 offen offset:3072 sc1 lds
    s_add_u32 s31, s31, 16384
    s_add_u32 m0, s30, 114688
    s_nop 0
    buffer_load_dwordx4 v1, s[16:19], s31 offen offset:0 sc1 lds
    buffer_load_dwordx4 v1, s[16:19], s31 offen offset:1024 sc1 lds
    buffer_load_dwordx4 v1, s[16:19], s31 offen offset:2048 sc1 lds
    buffer_load_dwordx4 v1, s[16:19], s31 offen offset:3072 sc1 lds
    s_add_u32 s31, s31, 16384
    s_waitcnt vmcnt(4)
    s_barrier
    s_add_u32 m0, s30, 131072
    s_nop 0
    buffer_load_dwordx4 v1, s[16:19], s31 offen offset:0 sc1 lds
    buffer_load_dwordx4 v1, s[16:19], s31 offen offset:1024 sc1 lds
    buffer_load_dwordx4 v1, s[16:19], s31 offen offset:2048 sc1 lds
    buffer_load_dwordx4 v1, s[16:19], s31 offen offset:3072 sc1 lds
    s_add_u32 s31, s31, 16384
    s_waitcnt vmcnt(4)
    s_barrier
    s_add_u32 m0, s30, 81920
    s_nop 0
    buffer_load_dwordx4 v1, s[16:19], s31 offen offset:0 sc1 lds
    buffer_load_dwordx4 v1, s[16:19], s31 offen offset:1024 sc1 lds
    buffer_load_dwordx4 v1, s[16:19], s31 offen offset:2048 sc1 lds
    buffer_load_dwordx4 v1, s[16:19], s31 offen offset:3072 sc1 lds
    s_add_u32 s31, s31, 16384
    s_waitcnt vmcnt(4)
    s_barrier
    s_add_u32 m0, s30, 98304
    s_nop 0
    buffer_load_dwordx4 v1, s[16:19], s31 offen offset:0 sc1 lds
    buffer_load_dwordx4 v1, s[16:19], s31 offen offset:1024 sc1 lds
    buffer_load_dwordx4 v1, s[16:19], s31 offen offset:2048 sc1 lds
    buffer_load_dwordx4 v1, s[16:19], s31 offen offset:3072 sc1 lds
    s_add_u32 s31, s31, 16384
    s_waitcnt vmcnt(4)
    s_barrier
    s_lshl_b32 s25, s2, 7
    s_add_u32 s25, s25, 18186240
    s_mov_b32 s97, 159780
    s_cmp_eq_u32 s26, 0
    s_cbranch_scc0 PSO_9
    s_mov_b32 s96, 300000
    v_mov_b32 v239, 0
POLL_11:
    buffer_load_dword v238, v239, s[16:19], s25 offen sc1
    s_waitcnt vmcnt(0)
    v_cmp_gt_u32 vcc, 12, v238
    s_sub_u32 s96, s96, 1
    s_cbranch_vccz POLLD_12
    s_sleep 1
    s_cmp_lg_u32 s96, 0
    s_cbranch_scc1 POLL_11
POLLD_12:
    v_mov_b32 v238, s97
    v_mov_b32 v239, 1
    s_waitcnt lgkmcnt(0)
    ds_write_b32 v238, v239
    s_branch PSD_10
PSO_9:
    v_mov_b32 v238, s97
LFW_13:
    s_sleep 1
    ds_read_b32 v239, v238
    s_waitcnt lgkmcnt(0)
    v_cmp_eq_u32 vcc, 0, v239
    s_nop 0
    s_cbranch_vccnz LFW_13
PSD_10:
    s_lshl_b32 s25, s23, 15
    s_lshl_b32 s27, s26, 10
    s_add_u32 s25, s25, s27
    s_add_u32 s25, s25, 17104896
    buffer_load_dwordx4 v[16:19], v1, s[16:19], s25 offen sc1
    s_add_u32 s25, s25, 4096
    buffer_load_dwordx4 v[20:23], v1, s[16:19], s25 offen sc1
    s_add_u32 s25, s25, 4096
    buffer_load_dwordx4 v[24:27], v1, s[16:19], s25 offen sc1
    s_add_u32 s25, s25, 4096
    buffer_load_dwordx4 v[28:31], v1, s[16:19], s25 offen sc1
    s_add_u32 s25, s25, 4096
    buffer_load_dwordx4 v[32:35], v1, s[16:19], s25 offen sc1
    s_add_u32 s25, s25, 4096
    buffer_load_dwordx4 v[36:39], v1, s[16:19], s25 offen sc1
    s_add_u32 s25, s25, 4096
    buffer_load_dwordx4 v[40:43], v1, s[16:19], s25 offen sc1
    s_add_u32 s25, s25, 4096
    buffer_load_dwordx4 v[44:47], v1, s[16:19], s25 offen sc1
    v_and_b32 v6, 31, v2
    v_lshlrev_b32 v6, 2, v6
    v_lshl_add_u32 v6, v7, 9, v6
    s_lshl_b32 s25, s23, 10
    s_add_u32 s25, s25, 18153472
    buffer_load_dword v48, v6, s[16:19], s25 offen offset:0 sc1
    buffer_load_dword v49, v6, s[16:19], s25 offen offset:128 sc1
    buffer_load_dword v50, v6, s[16:19], s25 offen offset:256 sc1
    buffer_load_dword v51, v6, s[16:19], s25 offen offset:384 sc1
    s_add_u32 s68, s29, 0
    s_add_u32 s69, s68, 65792
    buffer_load_dwordx4 v[52:55], v1, s[16:19], s68 offen offset:0 sc1
    buffer_load_dwordx4 v[56:59], v1, s[16:19], s68 offen offset:1024 sc1
    buffer_load_dwordx4 v[60:63], v1, s[16:19], s69 offen offset:0 sc1
    buffer_load_dwordx4 v[64:67], v1, s[16:19], s69 offen offset:1024 sc1
    s_add_u32 m0, s30, 114688
    s_nop 0
    buffer_load_dwordx4 v1, s[16:19], s31 offen offset:0 sc1 lds
    buffer_load_dwordx4 v1, s[16:19], s31 offen offset:1024 sc1 lds
    buffer_load_dwordx4 v1, s[16:19], s31 offen offset:2048 sc1 lds
    buffer_load_dwordx4 v1, s[16:19], s31 offen offset:3072 sc1 lds
    s_add_u32 s31, s31, 16384
    s_waitcnt vmcnt(20)
    s_barrier
    s_add_u32 m0, s30, 131072
    s_nop 0
    buffer_load_dwordx4 v1, s[16:19], s31 offen offset:0 sc1 lds
    buffer_load_dwordx4 v1, s[16:19], s31 offen offset:1024 sc1 lds
    buffer_load_dwordx4 v1, s[16:19], s31 offen offset:2048 sc1 lds
    buffer_load_dwordx4 v1, s[16:19], s31 offen offset:3072 sc1 lds
    s_add_u32 s31, s31, 16384
    s_mov_b32 s64, s44
    s_and_b32 s65, s45, 0xffff
    s_mov_b32 s66, 2097152
    s_mov_b32 s67, 0x20000
    v_lshlrev_b32 v8, 11, v2
    s_and_b32 s25, s89, 3
    s_lshl_b32 s25, s25, 2
    s_add_u32 s25, s25, s26
    s_lshl_b32 s25, s25, 17
    s_lshl_b32 s27, s90, 7
    s_add_u32 s25, s25, s27
    buffer_load_dword v237, v8, s[64:67], s25 offen
    s_waitcnt vmcnt(5)
    s_barrier
    s_add_u32 m0, s30, 81920
    s_nop 0
    buffer_load_dwordx4 v1, s[16:19], s31 offen offset:0 sc1 lds
    buffer_load_dwordx4 v1, s[16:19], s31 offen offset:1024 sc1 lds
    buffer_load_dwordx4 v1, s[16:19], s31 offen offset:2048 sc1 lds
    buffer_load_dwordx4 v1, s[16:19], s31 offen offset:3072 sc1 lds
    s_add_u32 s31, s31, 16384
    v_pk_add_f32 v[16:17], v[16:17], v[32:33]
    v_pk_add_f32 v[18:19], v[18:19], v[34:35]
    v_pk_add_f32 v[20:21], v[20:21], v[36:37]
    v_pk_add_f32 v[22:23], v[22:23], v[38:39]
    v_pk_add_f32 v[24:25], v[24:25], v[40:41]
    v_pk_add_f32 v[26:27], v[26:27], v[42:43]
    v_pk_add_f32 v[28:29], v[28:29], v[44:45]
    v_pk_add_f32 v[30:31], v[30:31], v[46:47]
    v_pk_add_f32 v[16:17], v[16:17], v[24:25]
    v_pk_add_f32 v[18:19], v[18:19], v[26:27]
    v_pk_add_f32 v[20:21], v[20:21], v[28:29]
    v_pk_add_f32 v[22:23], v[22:23], v[30:31]
    v_pk_add_f32 v[16:17], v[16:17], v[20:21]
    v_pk_add_f32 v[18:19], v[18:19], v[22:23]
    s_lshr_b32 s25, s26, 1
    s_lshl_b32 s25, s25, 10
    s_and_b32 s27, s26, 1
    s_lshl_b32 s27, s27, 3
    s_add_u32 s25, s25, s27
    s_add_u32 s25, s25, 161792
    v_add_u32 v8, s25, v1
    v_cvt_pk_bf16_f32 v16, v16, v17
    v_cvt_pk_bf16_f32 v17, v18, v19
    ds_write_b64 v8, v[16:17]
    s_cmp_eq_u32 s26, 0
    s_cbranch_scc0 K2_NOZ
    v_pk_add_f32 v[48:49], v[48:49], v[50:51]
    v_and_b32 v9, 31, v2
    v_add_f32 v48, v48, v49
    v_lshlrev_b32 v9, 1, v9
    v_mov_b32 v49, v48
    v_add_u32 v9, 159808, v9
    s_nop 0
    v_permlane32_swap_b32 v48, v49
    v_add_f32 v48, v48, v49
    v_cvt_pk_bf16_f32 v48, v48, v48
    ds_write_b16 v9, v48
K2_NOZ:
    s_waitcnt lgkmcnt(0)
    s_waitcnt vmcnt(5)
    s_barrier
    s_add_u32 m0, s30, 98304
    s_nop 0
    buffer_load_dwordx4 v1, s[16:19], s31 offen offset:0 sc1 lds
    buffer_load_dwordx4 v1, s[16:19], s31 offen offset:1024 sc1 lds
    buffer_load_dwordx4 v1, s[16:19], s31 offen offset:2048 sc1 lds
    buffer_load_dwordx4 v1, s[16:19], s31 offen offset:3072 sc1 lds
    s_add_u32 s31, s31, 16384
    v_lshlrev_b32 v10, 3, v7
    v_add_u32 v10, 159808, v10
    v_add_u32 v11, 161792, v1
    ds_read2_b64 v[76:79], v10 offset0:0 offset1:4
    ds_read2_b64 v[80:83], v10 offset0:2 offset1:6
    ds_read_b128 v[68:71], v11
    ds_read_b128 v[72:75], v11 offset:1024
    s_add_u32 s68, s29, 8421376
    s_add_u32 s69, s68, 65792
    s_waitcnt lgkmcnt(0)
    v_mfma_f32_32x32x16_bf16 v[100:115], v[76:79], v[52:55], 0
    v_mfma_f32_32x32x16_bf16 v[100:115], v[80:83], v[56:59], v[100:115]
    v_mfma_f32_32x32x16_bf16 v[84:99], v[68:71], v[52:55], 0
    v_mfma_f32_32x32x16_bf16 v[84:99], v[72:75], v[56:59], v[84:99]
    v_mfma_f32_32x32x16_bf16 v[32:47], v[76:79], v[60:63], 0
    v_mfma_f32_32x32x16_bf16 v[32:47], v[80:83], v[64:67], v[32:47]
    v_mfma_f32_32x32x16_bf16 v[16:31], v[68:71], v[60:63], 0
    v_mfma_f32_32x32x16_bf16 v[16:31], v[72:75], v[64:67], v[16:31]
    s_nop 7
    v_add_f32 v8, 0x358637bd, v100
    v_rcp_f32 v8, v8
    s_nop 0
    v_mov_b32 v9, v8
    v_pk_mul_f32 v[84:85], v[84:85], v[8:9]
    v_pk_mul_f32 v[86:87], v[86:87], v[8:9]
    v_pk_mul_f32 v[88:89], v[88:89], v[8:9]
    v_pk_mul_f32 v[90:91], v[90:91], v[8:9]
    v_pk_mul_f32 v[92:93], v[92:93], v[8:9]
    v_pk_mul_f32 v[94:95], v[94:95], v[8:9]
    v_pk_mul_f32 v[96:97], v[96:97], v[8:9]
    v_pk_mul_f32 v[98:99], v[98:99], v[8:9]
    v_cvt_pk_bf16_f32 v84, v84, v85
    v_cvt_pk_bf16_f32 v85, v86, v87
    v_cvt_pk_bf16_f32 v86, v88, v89
    v_cvt_pk_bf16_f32 v87, v90, v91
    v_cvt_pk_bf16_f32 v88, v92, v93
    v_cvt_pk_bf16_f32 v89, v94, v95
    v_cvt_pk_bf16_f32 v90, v96, v97
    v_cvt_pk_bf16_f32 v91, v98, v99
    buffer_store_dwordx4 v[84:87], v1, s[16:19], s68 offen offset:0 sc1
    buffer_store_dwordx4 v[88:91], v1, s[16:19], s68 offen offset:1024 sc1
    v_add_f32 v8, 0x358637bd, v32
    v_rcp_f32 v8, v8
    s_nop 0
    v_mov_b32 v9, v8
    v_pk_mul_f32 v[16:17], v[16:17], v[8:9]
    v_pk_mul_f32 v[18:19], v[18:19], v[8:9]
    v_pk_mul_f32 v[20:21], v[20:21], v[8:9]
    v_pk_mul_f32 v[22:23], v[22:23], v[8:9]
    v_pk_mul_f32 v[24:25], v[24:25], v[8:9]
    v_pk_mul_f32 v[26:27], v[26:27], v[8:9]
    v_pk_mul_f32 v[28:29], v[28:29], v[8:9]
    v_pk_mul_f32 v[30:31], v[30:31], v[8:9]
    v_cvt_pk_bf16_f32 v16, v16, v17
    v_cvt_pk_bf16_f32 v17, v18, v19
    v_cvt_pk_bf16_f32 v18, v20, v21
    v_cvt_pk_bf16_f32 v19, v22, v23
    v_cvt_pk_bf16_f32 v20, v24, v25
    v_cvt_pk_bf16_f32 v21, v26, v27
    v_cvt_pk_bf16_f32 v22, v28, v29
    v_cvt_pk_bf16_f32 v23, v30, v31
    buffer_store_dwordx4 v[16:19], v1, s[16:19], s69 offen offset:0 sc1
    buffer_store_dwordx4 v[20:23], v1, s[16:19], s69 offen offset:1024 sc1
    s_waitcnt vmcnt(8)
    s_barrier
    s_lshl_b32 s70, s24, 12
    s_add_u32 s70, s70, 18219008
    v_lshlrev_b32 v10, 7, v2
    v_mov_b32 v8, 159748
    v_mov_b32 v9, 1
    s_mov_b64 exec, 1
    s_waitcnt vmcnt(0)
    ds_add_rtn_u32 v8, v8, v9
    s_waitcnt lgkmcnt(0)
    v_readfirstlane_b32 s96, v8
    s_mov_b32 exec_lo, -1
    s_cmp_eq_u32 s96, 3
    s_cbranch_scc0 SIG_14
    buffer_atomic_add v9, v10, s[16:19], s70 offen offset:0 sc1
SIG_14:
    s_mov_b64 exec, -1
    s_add_u32 m0, s30, 114688
    s_nop 0
    buffer_load_dwordx4 v1, s[16:19], s31 offen offset:0 sc1 lds
    buffer_load_dwordx4 v1, s[16:19], s31 offen offset:1024 sc1 lds
    buffer_load_dwordx4 v1, s[16:19], s31 offen offset:2048 sc1 lds
    buffer_load_dwordx4 v1, s[16:19], s31 offen offset:3072 sc1 lds
    s_add_u32 s31, s31, 16384
    s_mov_b32 s64, s54
    s_and_b32 s65, s55, 0xffff
    s_mov_b32 s66, 2097152
    s_mov_b32 s67, 0x20000
    v_lshlrev_b32 v8, 11, v2
    s_and_b32 s25, s89, 3
    s_lshl_b32 s25, s25, 2
    s_add_u32 s25, s25, s26
    s_lshl_b32 s25, s25, 17
    s_lshl_b32 s27, s90, 7
    s_add_u32 s25, s25, s27
    buffer_load_dword v237, v8, s[64:67], s25 offen
    s_mov_b32 s4, s44
    s_and_b32 s5, s45, 0xffff
    s_mov_b32 s6, 2097152
    s_mov_b32 s7, 0x20000
    v_and_b32 v5, 7, v2
    v_bfe_u32 v4, v2, 4, 2
    v_lshlrev_b32 v4, 1, v4
    v_xor_b32 v4, v4, v5
    s_lshl_b32 s25, s90, 7
    v_lshl_add_u32 v4, v4, 4, s25
    v_lshrrev_b32 v5, 3, v2
    v_lshl_add_u32 v236, v5, 11, v4
    s_lshl_b32 s76, s26, 14
    s_and_b32 s78, s90, 0
    s_lshl_b32 s78, s78, 1
    s_lshl_b32 s25, s78, 17
    s_add_u32 s76, s76, s25
    s_lshl_b32 s78, s78, 12
    s_lshl_b32 s80, s26, 10
    s_mov_b32 s8, s56
    s_and_b32 s9, s57, 0xffff
    s_mov_b32 s10, 8388608
    s_mov_b32 s11, 0x20000
    v_lshrrev_b32 v4, 5, v2
    v_bfe_u32 v5, v2, 2, 3
    v_lshl_add_u32 v6, v4, 4, v5
    v_and_b32 v5, 6, v5
    v_lshlrev_b32 v5, 4, v5
    v_and_b32 v7, 3, v2
    v_lshl_add_u32 v5, v7, 3, v5
    v_lshl_add_u32 v240, v6, 7, v5
    v_xor_b32 v241, 32, v240
    v_xor_b32 v242, 64, v240
    v_xor_b32 v243, 96, v240
    v_and_b32 v5, 15, v2
    v_lshrrev_b32 v6, 4, v2
    v_lshlrev_b32 v7, 4, v5
    v_lshl_add_u32 v244, v6, 9, v7
    s_lshl_b32 s25, s26, 12
    s_add_u32 s25, s25, 65536
    v_and_b32 v7, 7, v2
    v_lshl_add_u32 v5, v5, 7, s25
    v_and_b32 v6, 1, v6
    v_lshl_add_u32 v5, v6, 3, v5
    v_xor_b32 v6, v7, v4
    v_lshl_add_u32 v246, v6, 4, v5
    v_xor_b32 v247, 32, v246
    v_xor_b32 v248, 64, v246
    v_xor_b32 v249, 96, v246
    v_lshrrev_b32 v5, 3, v2
    v_xor_b32 v6, v5, v7
    v_lshl_add_u32 v250, v5, 7, s25
    v_lshl_add_u32 v250, v6, 4, v250
    v_lshlrev_b32 v5, 12, v5
    v_lshl_add_u32 v251, v7, 4, v5
    s_lshl_b32 s25, s89, 2
    s_add_u32 s25, s25, s26
    s_lshl_b32 s72, s25, 17
    s_lshl_b32 s27, s90, 7
    s_add_u32 s72, s72, s27
    s_mul_i32 s77, s25, 65792
    s_add_u32 s77, s77, 8421376
    s_add_u32 s71, s77, s78
    s_mov_b32 s73, 65536
    v_pk_mov_b32 v[204:205], 0, 0
    v_pk_mov_b32 v[206:207], 0, 0
    v_pk_mov_b32 v[208:209], 0, 0
    v_pk_mov_b32 v[210:211], 0, 0
    v_pk_mov_b32 v[212:213], 0, 0
    v_pk_mov_b32 v[214:215], 0, 0
    v_pk_mov_b32 v[216:217], 0, 0
    v_pk_mov_b32 v[218:219], 0, 0
    v_pk_mov_b32 v[220:221], 0, 0
    v_pk_mov_b32 v[222:223], 0, 0
    v_pk_mov_b32 v[224:225], 0, 0
    v_pk_mov_b32 v[226:227], 0, 0
    v_pk_mov_b32 v[228:229], 0, 0
    v_pk_mov_b32 v[230:231], 0, 0
    v_pk_mov_b32 v[232:233], 0, 0
    v_pk_mov_b32 v[234:235], 0, 0
    s_barrier
    s_add_u32 m0, s30, 131072
    s_nop 0
    buffer_load_dwordx4 v1, s[16:19], s31 offen offset:0 sc1 lds
    buffer_load_dwordx4 v1, s[16:19], s31 offen offset:1024 sc1 lds
    buffer_load_dwordx4 v1, s[16:19], s31 offen offset:2048 sc1 lds
    buffer_load_dwordx4 v1, s[16:19], s31 offen offset:3072 sc1 lds
    s_add_u32 s31, s31, 16384
    s_add_u32 m0, s80, 0
    s_add_u32 s25, s76, 0
    s_and_b32 s25, s25, 2097151
    buffer_load_dwordx4 v236, s[4:7], s25 offen lds
    s_add_u32 m0, s80, 4096
    s_add_u32 s25, s76, 65536
    s_and_b32 s25, s25, 2097151
    buffer_load_dwordx4 v236, s[4:7], s25 offen lds
    s_add_u32 m0, s80, 8192
    s_add_u32 s25, s76, 131072
    s_and_b32 s25, s25, 2097151
    buffer_load_dwordx4 v236, s[4:7], s25 offen lds
    s_add_u32 m0, s80, 12288
    s_add_u32 s25, s76, 196608
    s_and_b32 s25, s25, 2097151
    buffer_load_dwordx4 v236, s[4:7], s25 offen lds
    s_add_u32 m0, s80, 16384
    s_add_u32 s25, s76, 262144
    s_and_b32 s25, s25, 2097151
    buffer_load_dwordx4 v236, s[4:7], s25 offen lds
    s_add_u32 m0, s80, 20480
    s_add_u32 s25, s76, 327680
    s_and_b32 s25, s25, 2097151
    buffer_load_dwordx4 v236, s[4:7], s25 offen lds
    s_add_u32 m0, s80, 24576
    s_add_u32 s25, s76, 393216
    s_and_b32 s25, s25, 2097151
    buffer_load_dwordx4 v236, s[4:7], s25 offen lds
    s_add_u32 m0, s80, 28672
    s_add_u32 s25, s76, 458752
    s_and_b32 s25, s25, 2097151
    buffer_load_dwordx4 v236, s[4:7], s25 offen lds
    s_add_u32 m0, s80, 32768
    s_add_u32 s25, s76, 524288
    s_and_b32 s25, s25, 2097151
    buffer_load_dwordx4 v236, s[4:7], s25 offen lds
    s_add_u32 m0, s80, 36864
    s_add_u32 s25, s76, 589824
    s_and_b32 s25, s25, 2097151
    buffer_load_dwordx4 v236, s[4:7], s25 offen lds
    s_waitcnt vmcnt(15)
    s_barrier
    s_add_u32 m0, s30, 81920
    s_nop 0
    buffer_load_dwordx4 v1, s[16:19], s31 offen offset:0 sc1 lds
    buffer_load_dwordx4 v1, s[16:19], s31 offen offset:1024 sc1 lds
    buffer_load_dwordx4 v1, s[16:19], s31 offen offset:2048 sc1 lds
    buffer_load_dwordx4 v1, s[16:19], s31 offen offset:3072 sc1 lds
    s_add_u32 s31, s31, 16384
    s_add_u32 m0, s80, 40960
    s_add_u32 s25, s76, 655360
    s_and_b32 s25, s25, 2097151
    buffer_load_dwordx4 v236, s[4:7], s25 offen lds
    s_add_u32 m0, s80, 45056
    s_add_u32 s25, s76, 720896
    s_and_b32 s25, s25, 2097151
    buffer_load_dwordx4 v236, s[4:7], s25 offen lds
    s_add_u32 m0, s80, 49152
    s_add_u32 s25, s76, 786432
    s_and_b32 s25, s25, 2097151
    buffer_load_dwordx4 v236, s[4:7], s25 offen lds
    s_add_u32 m0, s80, 53248
    s_add_u32 s25, s76, 851968
    s_and_b32 s25, s25, 2097151
    buffer_load_dwordx4 v236, s[4:7], s25 offen lds
    s_add_u32 m0, s80, 57344
    s_add_u32 s25, s76, 917504
    s_and_b32 s25, s25, 2097151
    buffer_load_dwordx4 v236, s[4:7], s25 offen lds
    s_add_u32 m0, s80, 61440
    s_add_u32 s25, s76, 983040
    s_and_b32 s25, s25, 2097151
    buffer_load_dwordx4 v236, s[4:7], s25 offen lds
    s_add_u32 m0, s80, 65536
    s_add_u32 s25, s76, 1048576
    s_and_b32 s25, s25, 2097151
    buffer_load_dwordx4 v236, s[4:7], s25 offen lds
    s_add_u32 m0, s80, 69632
    s_add_u32 s25, s76, 1114112
    s_and_b32 s25, s25, 2097151
    buffer_load_dwordx4 v236, s[4:7], s25 offen lds
    s_add_u32 m0, s80, 73728
    s_add_u32 s25, s76, 1179648
    s_and_b32 s25, s25, 2097151
    buffer_load_dwordx4 v236, s[4:7], s25 offen lds
    s_add_u32 m0, s80, 77824
    s_add_u32 s25, s76, 1245184
    s_and_b32 s25, s25, 2097151
    buffer_load_dwordx4 v236, s[4:7], s25 offen lds
    s_waitcnt vmcnt(24)
    s_barrier
    s_add_u32 m0, s30, 98304
    s_nop 0
    buffer_load_dwordx4 v1, s[16:19], s31 offen offset:0 sc1 lds
    buffer_load_dwordx4 v1, s[16:19], s31 offen offset:1024 sc1 lds
    buffer_load_dwordx4 v1, s[16:19], s31 offen offset:2048 sc1 lds
    buffer_load_dwordx4 v1, s[16:19], s31 offen offset:3072 sc1 lds
    s_add_u32 s31, s31, 16384
    v_mov_b32 v239, 0
    buffer_load_dword v238, v239, s[16:19], s91 offen sc1
    s_waitcnt vmcnt(15)
    s_barrier
    s_add_u32 m0, s30, 114688
    s_nop 0
    buffer_load_dwordx4 v1, s[16:19], s31 offen offset:0 sc1 lds
    buffer_load_dwordx4 v1, s[16:19], s31 offen offset:1024 sc1 lds
    buffer_load_dwordx4 v1, s[16:19], s31 offen offset:2048 sc1 lds
    buffer_load_dwordx4 v1, s[16:19], s31 offen offset:3072 sc1 lds
    s_add_u32 s31, s31, 16384
    s_waitcnt vmcnt(4)
    s_mov_b32 s96, 300000
POLL_15:
    v_cmp_gt_u32 vcc, 32, v238
    s_sub_u32 s96, s96, 1
    s_cbranch_vccz POLLD_16
    s_sleep 8
    buffer_load_dword v238, v239, s[16:19], s91 offen sc1
    s_waitcnt vmcnt(0)
    s_cmp_lg_u32 s96, 0
    s_cbranch_scc1 POLL_15
POLLD_16:
    buffer_load_dwordx4 v[12:15], v244, s[16:19], s71 offen offset:0 sc1
    buffer_load_dwordx4 v[16:19], v244, s[16:19], s71 offen offset:256 sc1
    buffer_load_dwordx4 v[20:23], v244, s[16:19], s71 offen offset:2048 sc1
    buffer_load_dwordx4 v[24:27], v244, s[16:19], s71 offen offset:2304 sc1
    s_add_u32 s78, s78, 4096
    s_and_b32 s78, s78, 0xffff
    s_add_u32 s71, s77, s78
    buffer_load_dwordx4 v[28:31], v244, s[16:19], s71 offen offset:0 sc1
    buffer_load_dwordx4 v[32:35], v244, s[16:19], s71 offen offset:256 sc1
    buffer_load_dwordx4 v[36:39], v244, s[16:19], s71 offen offset:2048 sc1
    buffer_load_dwordx4 v[40:43], v244, s[16:19], s71 offen offset:2304 sc1
    s_add_u32 s78, s78, 4096
    s_and_b32 s78, s78, 0xffff
    s_add_u32 s71, s77, s78
    buffer_load_dwordx4 v[44:47], v244, s[16:19], s71 offen offset:0 sc1
    buffer_load_dwordx4 v[48:51], v244, s[16:19], s71 offen offset:256 sc1
    s_barrier
    s_add_u32 m0, s30, 131072
    s_nop 0
    buffer_load_dwordx4 v1, s[16:19], s31 offen offset:0 sc1 lds
    buffer_load_dwordx4 v1, s[16:19], s31 offen offset:1024 sc1 lds
    buffer_load_dwordx4 v1, s[16:19], s31 offen offset:2048 sc1 lds
    buffer_load_dwordx4 v1, s[16:19], s31 offen offset:3072 sc1 lds
    s_add_u32 s31, s31, 16384
    buffer_load_dwordx4 v[52:55], v244, s[16:19], s71 offen offset:2048 sc1
    buffer_load_dwordx4 v[56:59], v244, s[16:19], s71 offen offset:2304 sc1
    s_add_u32 s78, s78, 4096
    s_and_b32 s78, s78, 0xffff
    s_add_u32 s71, s77, s78
    buffer_load_dwordx4 v[60:63], v244, s[16:19], s71 offen offset:0 sc1
    buffer_load_dwordx4 v[64:67], v244, s[16:19], s71 offen offset:256 sc1
    buffer_load_dwordx4 v[68:71], v244, s[16:19], s71 offen offset:2048 sc1
    buffer_load_dwordx4 v[72:75], v244, s[16:19], s71 offen offset:2304 sc1
    s_add_u32 s78, s78, 4096
    s_and_b32 s78, s78, 0xffff
    s_add_u32 s71, s77, s78
    buffer_load_dwordx4 v[76:79], v244, s[16:19], s71 offen offset:0 sc1
    buffer_load_dwordx4 v[80:83], v244, s[16:19], s71 offen offset:256 sc1
    buffer_load_dwordx4 v[84:87], v244, s[16:19], s71 offen offset:2048 sc1
    buffer_load_dwordx4 v[88:91], v244, s[16:19], s71 offen offset:2304 sc1
    s_add_u32 s78, s78, 4096
    s_and_b32 s78, s78, 0xffff
    s_add_u32 s71, s77, s78
    s_waitcnt vmcnt(24)
    s_barrier
    buffer_load_dwordx4 v[92:95], v244, s[16:19], s71 offen offset:0 sc1
    buffer_load_dwordx4 v[96:99], v244, s[16:19], s71 offen offset:256 sc1
    buffer_load_dwordx4 v[100:103], v244, s[16:19], s71 offen offset:2048 sc1
    buffer_load_dwordx4 v[104:107], v244, s[16:19], s71 offen offset:2304 sc1
    s_add_u32 s78, s78, 4096
    s_and_b32 s78, s78, 0xffff
    s_add_u32 s71, s77, s78
    buffer_load_dwordx4 v[108:111], v244, s[16:19], s71 offen offset:0 sc1
    buffer_load_dwordx4 v[112:115], v244, s[16:19], s71 offen offset:256 sc1
    buffer_load_dwordx4 v[116:119], v244, s[16:19], s71 offen offset:2048 sc1
    buffer_load_dwordx4 v[120:123], v244, s[16:19], s71 offen offset:2304 sc1
    s_add_u32 s78, s78, 4096
    s_and_b32 s78, s78, 0xffff
    s_add_u32 s71, s77, s78
    buffer_load_dwordx4 v[124:127], v244, s[16:19], s71 offen offset:0 sc1
    buffer_load_dwordx4 v[128:131], v244, s[16:19], s71 offen offset:256 sc1
    s_waitcnt vmcnt(20)
    s_barrier
    buffer_load_dwordx4 v[132:135], v244, s[16:19], s71 offen offset:2048 sc1
    buffer_load_dwordx4 v[136:139], v244, s[16:19], s71 offen offset:2304 sc1
    s_add_u32 s78, s78, 4096
    s_and_b32 s78, s78, 0xffff
    s_add_u32 s71, s77, s78
    buffer_load_dwordx4 v[140:143], v244, s[16:19], s71 offen offset:0 sc1
    buffer_load_dwordx4 v[144:147], v244, s[16:19], s71 offen offset:256 sc1
    buffer_load_dwordx4 v[148:151], v244, s[16:19], s71 offen offset:2048 sc1
    buffer_load_dwordx4 v[152:155], v244, s[16:19], s71 offen offset:2304 sc1
    s_add_u32 s78, s78, 4096
    s_and_b32 s78, s78, 0xffff
    s_add_u32 s71, s77, s78
    buffer_load_dwordx4 v[156:159], v244, s[16:19], s71 offen offset:0 sc1
    buffer_load_dwordx4 v[160:163], v244, s[16:19], s71 offen offset:256 sc1
    buffer_load_dwordx4 v[164:167], v244, s[16:19], s71 offen offset:2048 sc1
    buffer_load_dwordx4 v[168:171], v244, s[16:19], s71 offen offset:2304 sc1
    s_add_u32 s78, s78, 4096
    s_and_b32 s78, s78, 0xffff
    s_add_u32 s71, s77, s78
    s_barrier
    s_setprio 0
    s_add_u32 m0, s80, 81920
    s_add_u32 s25, s76, 1310720
    s_and_b32 s25, s25, 2097151
    buffer_load_dwordx4 v236, s[4:7], s25 offen lds
    s_add_u32 m0, s80, 86016
    s_add_u32 s25, s76, 1376256
    s_and_b32 s25, s25, 2097151
    buffer_load_dwordx4 v236, s[4:7], s25 offen lds
    s_add_u32 m0, s80, 90112
    s_add_u32 s25, s76, 1441792
    s_and_b32 s25, s25, 2097151
    buffer_load_dwordx4 v236, s[4:7], s25 offen lds
    s_add_u32 m0, s80, 94208
    s_add_u32 s25, s76, 1507328
    s_and_b32 s25, s25, 2097151
    buffer_load_dwordx4 v236, s[4:7], s25 offen lds
    s_add_u32 m0, s80, 98304
    s_add_u32 s25, s76, 1572864
    s_and_b32 s25, s25, 2097151
    buffer_load_dwordx4 v236, s[4:7], s25 offen lds
    s_add_u32 m0, s80, 102400
    s_add_u32 s25, s76, 1638400
    s_and_b32 s25, s25, 2097151
    buffer_load_dwordx4 v236, s[4:7], s25 offen lds
    s_add_u32 m0, s80, 106496
    s_add_u32 s25, s76, 1703936
    s_and_b32 s25, s25, 2097151
    buffer_load_dwordx4 v236, s[4:7], s25 offen lds
    s_add_u32 m0, s80, 110592
    s_add_u32 s25, s76, 1769472
    s_and_b32 s25, s25, 2097151
    buffer_load_dwordx4 v236, s[4:7], s25 offen lds
    s_add_u32 m0, s80, 114688
    s_add_u32 s25, s76, 1835008
    s_and_b32 s25, s25, 2097151
    buffer_load_dwordx4 v236, s[4:7], s25 offen lds
    s_add_u32 m0, s80, 118784
    s_add_u32 s25, s76, 1900544
    s_and_b32 s25, s25, 2097151
    buffer_load_dwordx4 v236, s[4:7], s25 offen lds
    s_add_u32 m0, s80, 122880
    s_add_u32 s25, s76, 1966080
    s_and_b32 s25, s25, 2097151
    buffer_load_dwordx4 v236, s[4:7], s25 offen lds
    s_add_u32 m0, s80, 126976
    s_add_u32 s25, s76, 2031616
    s_and_b32 s25, s25, 2097151
    buffer_load_dwordx4 v236, s[4:7], s25 offen lds
    ds_read_b64_tr_b16 v[172:173], v240 offset:0
    ds_read_b64_tr_b16 v[174:175], v240 offset:1024
    ds_read_b64_tr_b16 v[176:177], v241 offset:0
    ds_read_b64_tr_b16 v[178:179], v241 offset:1024
    ds_read_b64_tr_b16 v[180:181], v242 offset:0
    ds_read_b64_tr_b16 v[182:183], v242 offset:1024
    ds_read_b64_tr_b16 v[184:185], v243 offset:0
    ds_read_b64_tr_b16 v[186:187], v243 offset:1024
    ds_read_b64_tr_b16 v[188:189], v240 offset:4096
    ds_read_b64_tr_b16 v[190:191], v240 offset:5120
    ds_read_b64_tr_b16 v[192:193], v241 offset:4096
    ds_read_b64_tr_b16 v[194:195], v241 offset:5120
    ds_read_b64_tr_b16 v[196:197], v242 offset:4096
    ds_read_b64_tr_b16 v[198:199], v242 offset:5120
    ds_read_b64_tr_b16 v[200:201], v243 offset:4096
    ds_read_b64_tr_b16 v[202:203], v243 offset:5120
    s_waitcnt vmcnt(50)
    s_waitcnt lgkmcnt(14)
    v_mfma_f32_16x16x32_bf16 v[204:207], v[172:175], v[12:15], v[204:207]
    v_mfma_f32_16x16x32_bf16 v[220:223], v[172:175], v[16:19], v[220:223]
    s_waitcnt lgkmcnt(12)
    ds_read_b64_tr_b16 v[172:173], v240 offset:8192
    v_mfma_f32_16x16x32_bf16 v[208:211], v[176:179], v[12:15], v[208:211]
    ds_read_b64_tr_b16 v[174:175], v240 offset:9216
    v_mfma_f32_16x16x32_bf16 v[224:227], v[176:179], v[16:19], v[224:227]
    s_waitcnt lgkmcnt(12)
    ds_read_b64_tr_b16 v[176:177], v241 offset:8192
    v_mfma_f32_16x16x32_bf16 v[212:215], v[180:183], v[12:15], v[212:215]
    ds_read_b64_tr_b16 v[178:179], v241 offset:9216
    v_mfma_f32_16x16x32_bf16 v[228:231], v[180:183], v[16:19], v[228:231]
    s_waitcnt lgkmcnt(12)
    ds_read_b64_tr_b16 v[180:181], v242 offset:8192
    v_mfma_f32_16x16x32_bf16 v[216:219], v[184:187], v[12:15], v[216:219]
    ds_read_b64_tr_b16 v[182:183], v242 offset:9216
    v_mfma_f32_16x16x32_bf16 v[232:235], v[184:187], v[16:19], v[232:235]
    s_waitcnt lgkmcnt(12)
    s_waitcnt vmcnt(48)
    ds_read_b64_tr_b16 v[184:185], v243 offset:8192
    v_mfma_f32_16x16x32_bf16 v[204:207], v[188:191], v[20:23], v[204:207]
    ds_read_b64_tr_b16 v[186:187], v243 offset:9216
    buffer_load_dwordx4 v[12:15], v244, s[16:19], s71 offen offset:0 sc1
    v_mfma_f32_16x16x32_bf16 v[220:223], v[188:191], v[24:27], v[220:223]
    s_waitcnt lgkmcnt(12)
    ds_read_b64_tr_b16 v[188:189], v240 offset:12288
    v_mfma_f32_16x16x32_bf16 v[208:211], v[192:195], v[20:23], v[208:211]
    ds_read_b64_tr_b16 v[190:191], v240 offset:13312
    buffer_load_dwordx4 v[16:19], v244, s[16:19], s71 offen offset:256 sc1
    v_mfma_f32_16x16x32_bf16 v[224:227], v[192:195], v[24:27], v[224:227]
    s_waitcnt lgkmcnt(12)
    ds_read_b64_tr_b16 v[192:193], v241 offset:12288
    v_mfma_f32_16x16x32_bf16 v[212:215], v[196:199], v[20:23], v[212:215]
    ds_read_b64_tr_b16 v[194:195], v241 offset:13312
    v_mfma_f32_16x16x32_bf16 v[228:231], v[196:199], v[24:27], v[228:231]
    s_waitcnt lgkmcnt(12)
    ds_read_b64_tr_b16 v[196:197], v242 offset:12288
    v_mfma_f32_16x16x32_bf16 v[216:219], v[200:203], v[20:23], v[216:219]
    ds_read_b64_tr_b16 v[198:199], v242 offset:13312
    v_mfma_f32_16x16x32_bf16 v[232:235], v[200:203], v[24:27], v[232:235]
    s_waitcnt lgkmcnt(12)
    s_waitcnt vmcnt(48)
    ds_read_b64_tr_b16 v[200:201], v243 offset:12288
    v_mfma_f32_16x16x32_bf16 v[204:207], v[172:175], v[28:31], v[204:207]
    ds_read_b64_tr_b16 v[202:203], v243 offset:13312
    buffer_load_dwordx4 v[20:23], v244, s[16:19], s71 offen offset:2048 sc1
    v_mfma_f32_16x16x32_bf16 v[220:223], v[172:175], v[32:35], v[220:223]
    s_waitcnt lgkmcnt(12)
    ds_read_b64_tr_b16 v[172:173], v240 offset:16384
    v_mfma_f32_16x16x32_bf16 v[208:211], v[176:179], v[28:31], v[208:211]
    ds_read_b64_tr_b16 v[174:175], v240 offset:17408
    buffer_load_dwordx4 v[24:27], v244, s[16:19], s71 offen offset:2304 sc1
    s_add_u32 s78, s78, 4096
    s_and_b32 s78, s78, 0xffff
    s_add_u32 s71, s77, s78
    v_mfma_f32_16x16x32_bf16 v[224:227], v[176:179], v[32:35], v[224:227]
    s_waitcnt lgkmcnt(12)
    ds_read_b64_tr_b16 v[176:177], v241 offset:16384
    v_mfma_f32_16x16x32_bf16 v[212:215], v[180:183], v[28:31], v[212:215]
    ds_read_b64_tr_b16 v[178:179], v241 offset:17408
    v_mfma_f32_16x16x32_bf16 v[228:231], v[180:183], v[32:35], v[228:231]
    s_waitcnt lgkmcnt(12)
    ds_read_b64_tr_b16 v[180:181], v242 offset:16384
    v_mfma_f32_16x16x32_bf16 v[216:219], v[184:187], v[28:31], v[216:219]
    ds_read_b64_tr_b16 v[182:183], v242 offset:17408
    v_mfma_f32_16x16x32_bf16 v[232:235], v[184:187], v[32:35], v[232:235]
    s_waitcnt lgkmcnt(12)
    s_waitcnt vmcnt(48)
    ds_read_b64_tr_b16 v[184:185], v243 offset:16384
    v_mfma_f32_16x16x32_bf16 v[204:207], v[188:191], v[36:39], v[204:207]
    ds_read_b64_tr_b16 v[186:187], v243 offset:17408
    buffer_load_dwordx4 v[28:31], v244, s[16:19], s71 offen offset:0 sc1
    v_mfma_f32_16x16x32_bf16 v[220:223], v[188:191], v[40:43], v[220:223]
    s_waitcnt lgkmcnt(12)
    ds_read_b64_tr_b16 v[188:189], v240 offset:20480
    v_mfma_f32_16x16x32_bf16 v[208:211], v[192:195], v[36:39], v[208:211]
    ds_read_b64_tr_b16 v[190:191], v240 offset:21504
    buffer_load_dwordx4 v[32:35], v244, s[16:19], s71 offen offset:256 sc1
    v_mfma_f32_16x16x32_bf16 v[224:227], v[192:195], v[40:43], v[224:227]
    s_waitcnt lgkmcnt(12)
    ds_read_b64_tr_b16 v[192:193], v241 offset:20480
    v_mfma_f32_16x16x32_bf16 v[212:215], v[196:199], v[36:39], v[212:215]
    ds_read_b64_tr_b16 v[194:195], v241 offset:21504
    v_mfma_f32_16x16x32_bf16 v[228:231], v[196:199], v[40:43], v[228:231]
    s_waitcnt lgkmcnt(12)
    ds_read_b64_tr_b16 v[196:197], v242 offset:20480
    v_mfma_f32_16x16x32_bf16 v[216:219], v[200:203], v[36:39], v[216:219]
    ds_read_b64_tr_b16 v[198:199], v242 offset:21504
    v_mfma_f32_16x16x32_bf16 v[232:235], v[200:203], v[40:43], v[232:235]
    s_waitcnt lgkmcnt(12)
    s_waitcnt vmcnt(48)
    ds_read_b64_tr_b16 v[200:201], v243 offset:20480
    v_mfma_f32_16x16x32_bf16 v[204:207], v[172:175], v[44:47], v[204:207]
    ds_read_b64_tr_b16 v[202:203], v243 offset:21504
    buffer_load_dwordx4 v[36:39], v244, s[16:19], s71 offen offset:2048 sc1
    v_mfma_f32_16x16x32_bf16 v[220:223], v[172:175], v[48:51], v[220:223]
    s_waitcnt lgkmcnt(12)
    ds_read_b64_tr_b16 v[172:173], v240 offset:24576
    v_mfma_f32_16x16x32_bf16 v[208:211], v[176:179], v[44:47], v[208:211]
    ds_read_b64_tr_b16 v[174:175], v240 offset:25600
    buffer_load_dwordx4 v[40:43], v244, s[16:19], s71 offen offset:2304 sc1
    s_add_u32 s78, s78, 4096
    s_and_b32 s78, s78, 0xffff
    s_add_u32 s71, s77, s78
    v_mfma_f32_16x16x32_bf16 v[224:227], v[176:179], v[48:51], v[224:227]
    s_waitcnt lgkmcnt(12)
    ds_read_b64_tr_b16 v[176:177], v241 offset:24576
    v_mfma_f32_16x16x32_bf16 v[212:215], v[180:183], v[44:47], v[212:215]
    ds_read_b64_tr_b16 v[178:179], v241 offset:25600
    v_mfma_f32_16x16x32_bf16 v[228:231], v[180:183], v[48:51], v[228:231]
    s_waitcnt lgkmcnt(12)
    ds_read_b64_tr_b16 v[180:181], v242 offset:24576
    v_mfma_f32_16x16x32_bf16 v[216:219], v[184:187], v[44:47], v[216:219]
    ds_read_b64_tr_b16 v[182:183], v242 offset:25600
    v_mfma_f32_16x16x32_bf16 v[232:235], v[184:187], v[48:51], v[232:235]
    s_waitcnt lgkmcnt(12)
    s_waitcnt vmcnt(48)
    ds_read_b64_tr_b16 v[184:185], v243 offset:24576
    v_mfma_f32_16x16x32_bf16 v[204:207], v[188:191], v[52:55], v[204:207]
    ds_read_b64_tr_b16 v[186:187], v243 offset:25600
    buffer_load_dwordx4 v[44:47], v244, s[16:19], s71 offen offset:0 sc1
    v_mfma_f32_16x16x32_bf16 v[220:223], v[188:191], v[56:59], v[220:223]
    s_waitcnt lgkmcnt(12)
    ds_read_b64_tr_b16 v[188:189], v240 offset:28672
    v_mfma_f32_16x16x32_bf16 v[208:211], v[192:195], v[52:55], v[208:211]
    ds_read_b64_tr_b16 v[190:191], v240 offset:29696
    buffer_load_dwordx4 v[48:51], v244, s[16:19], s71 offen offset:256 sc1
    v_mfma_f32_16x16x32_bf16 v[224:227], v[192:195], v[56:59], v[224:227]
    s_waitcnt lgkmcnt(12)
    ds_read_b64_tr_b16 v[192:193], v241 offset:28672
    v_mfma_f32_16x16x32_bf16 v[212:215], v[196:199], v[52:55], v[212:215]
    ds_read_b64_tr_b16 v[194:195], v241 offset:29696
    v_mfma_f32_16x16x32_bf16 v[228:231], v[196:199], v[56:59], v[228:231]
    s_waitcnt lgkmcnt(12)
    ds_read_b64_tr_b16 v[196:197], v242 offset:28672
    v_mfma_f32_16x16x32_bf16 v[216:219], v[200:203], v[52:55], v[216:219]
    ds_read_b64_tr_b16 v[198:199], v242 offset:29696
    v_mfma_f32_16x16x32_bf16 v[232:235], v[200:203], v[56:59], v[232:235]
    s_waitcnt lgkmcnt(12)
    s_waitcnt vmcnt(48)
    ds_read_b64_tr_b16 v[200:201], v243 offset:28672
    v_mfma_f32_16x16x32_bf16 v[204:207], v[172:175], v[60:63], v[204:207]
    ds_read_b64_tr_b16 v[202:203], v243 offset:29696
    buffer_load_dwordx4 v[52:55], v244, s[16:19], s71 offen offset:2048 sc1
    v_mfma_f32_16x16x32_bf16 v[220:223], v[172:175], v[64:67], v[220:223]
    s_waitcnt lgkmcnt(12)
    ds_read_b64_tr_b16 v[172:173], v240 offset:32768
    v_mfma_f32_16x16x32_bf16 v[208:211], v[176:179], v[60:63], v[208:211]
    ds_read_b64_tr_b16 v[174:175], v240 offset:33792
    buffer_load_dwordx4 v[56:59], v244, s[16:19], s71 offen offset:2304 sc1
    s_add_u32 s78, s78, 4096
    s_and_b32 s78, s78, 0xffff
    s_add_u32 s71, s77, s78
    v_mfma_f32_16x16x32_bf16 v[224:227], v[176:179], v[64:67], v[224:227]
    s_waitcnt lgkmcnt(12)
    ds_read_b64_tr_b16 v[176:177], v241 offset:32768
    v_mfma_f32_16x16x32_bf16 v[212:215], v[180:183], v[60:63], v[212:215]
    ds_read_b64_tr_b16 v[178:179], v241 offset:33792
    v_mfma_f32_16x16x32_bf16 v[228:231], v[180:183], v[64:67], v[228:231]
    s_waitcnt lgkmcnt(12)
    ds_read_b64_tr_b16 v[180:181], v242 offset:32768
    v_mfma_f32_16x16x32_bf16 v[216:219], v[184:187], v[60:63], v[216:219]
    ds_read_b64_tr_b16 v[182:183], v242 offset:33792
    v_mfma_f32_16x16x32_bf16 v[232:235], v[184:187], v[64:67], v[232:235]
    s_waitcnt lgkmcnt(12)
    s_waitcnt vmcnt(48)
    ds_read_b64_tr_b16 v[184:185], v243 offset:32768
    v_mfma_f32_16x16x32_bf16 v[204:207], v[188:191], v[68:71], v[204:207]
    ds_read_b64_tr_b16 v[186:187], v243 offset:33792
    buffer_load_dwordx4 v[60:63], v244, s[16:19], s71 offen offset:0 sc1
    v_mfma_f32_16x16x32_bf16 v[220:223], v[188:191], v[72:75], v[220:223]
    s_waitcnt lgkmcnt(12)
    ds_read_b64_tr_b16 v[188:189], v240 offset:36864
    v_mfma_f32_16x16x32_bf16 v[208:211], v[192:195], v[68:71], v[208:211]
    ds_read_b64_tr_b16 v[190:191], v240 offset:37888
    buffer_load_dwordx4 v[64:67], v244, s[16:19], s71 offen offset:256 sc1
    v_mfma_f32_16x16x32_bf16 v[224:227], v[192:195], v[72:75], v[224:227]
    s_waitcnt lgkmcnt(12)
    ds_read_b64_tr_b16 v[192:193], v241 offset:36864
    v_mfma_f32_16x16x32_bf16 v[212:215], v[196:199], v[68:71], v[212:215]
    ds_read_b64_tr_b16 v[194:195], v241 offset:37888
    v_mfma_f32_16x16x32_bf16 v[228:231], v[196:199], v[72:75], v[228:231]
    s_waitcnt lgkmcnt(12)
    ds_read_b64_tr_b16 v[196:197], v242 offset:36864
    v_mfma_f32_16x16x32_bf16 v[216:219], v[200:203], v[68:71], v[216:219]
    ds_read_b64_tr_b16 v[198:199], v242 offset:37888
    v_mfma_f32_16x16x32_bf16 v[232:235], v[200:203], v[72:75], v[232:235]
    s_waitcnt lgkmcnt(12)
    s_waitcnt vmcnt(48)
    ds_read_b64_tr_b16 v[200:201], v243 offset:36864
    v_mfma_f32_16x16x32_bf16 v[204:207], v[172:175], v[76:79], v[204:207]
    ds_read_b64_tr_b16 v[202:203], v243 offset:37888
    buffer_load_dwordx4 v[68:71], v244, s[16:19], s71 offen offset:2048 sc1
    v_mfma_f32_16x16x32_bf16 v[220:223], v[172:175], v[80:83], v[220:223]
    s_waitcnt lgkmcnt(12)
    ds_read_b64_tr_b16 v[172:173], v240 offset:40960
    v_mfma_f32_16x16x32_bf16 v[208:211], v[176:179], v[76:79], v[208:211]
    ds_read_b64_tr_b16 v[174:175], v240 offset:41984
    buffer_load_dwordx4 v[72:75], v244, s[16:19], s71 offen offset:2304 sc1
    s_add_u32 s78, s78, 4096
    s_and_b32 s78, s78, 0xffff
    s_add_u32 s71, s77, s78
    v_mfma_f32_16x16x32_bf16 v[224:227], v[176:179], v[80:83], v[224:227]
    s_waitcnt lgkmcnt(12)
    ds_read_b64_tr_b16 v[176:177], v241 offset:40960
    v_mfma_f32_16x16x32_bf16 v[212:215], v[180:183], v[76:79], v[212:215]
    ds_read_b64_tr_b16 v[178:179], v241 offset:41984
    v_mfma_f32_16x16x32_bf16 v[228:231], v[180:183], v[80:83], v[228:231]
    s_waitcnt lgkmcnt(12)
    ds_read_b64_tr_b16 v[180:181], v242 offset:40960
    v_mfma_f32_16x16x32_bf16 v[216:219], v[184:187], v[76:79], v[216:219]
    ds_read_b64_tr_b16 v[182:183], v242 offset:41984
    v_mfma_f32_16x16x32_bf16 v[232:235], v[184:187], v[80:83], v[232:235]
    s_waitcnt lgkmcnt(12)
    s_waitcnt vmcnt(48)
    ds_read_b64_tr_b16 v[184:185], v243 offset:40960
    v_mfma_f32_16x16x32_bf16 v[204:207], v[188:191], v[84:87], v[204:207]
    ds_read_b64_tr_b16 v[186:187], v243 offset:41984
    buffer_load_dwordx4 v[76:79], v244, s[16:19], s71 offen offset:0 sc1
    v_mfma_f32_16x16x32_bf16 v[220:223], v[188:191], v[88:91], v[220:223]
    s_waitcnt lgkmcnt(12)
    ds_read_b64_tr_b16 v[188:189], v240 offset:45056
    v_mfma_f32_16x16x32_bf16 v[208:211], v[192:195], v[84:87], v[208:211]
    ds_read_b64_tr_b16 v[190:191], v240 offset:46080
    buffer_load_dwordx4 v[80:83], v244, s[16:19], s71 offen offset:256 sc1
    v_mfma_f32_16x16x32_bf16 v[224:227], v[192:195], v[88:91], v[224:227]
    s_waitcnt lgkmcnt(12)
    ds_read_b64_tr_b16 v[192:193], v241 offset:45056
    v_mfma_f32_16x16x32_bf16 v[212:215], v[196:199], v[84:87], v[212:215]
    ds_read_b64_tr_b16 v[194:195], v241 offset:46080
    v_mfma_f32_16x16x32_bf16 v[228:231], v[196:199], v[88:91], v[228:231]
    s_waitcnt lgkmcnt(12)
    ds_read_b64_tr_b16 v[196:197], v242 offset:45056
    v_mfma_f32_16x16x32_bf16 v[216:219], v[200:203], v[84:87], v[216:219]
    ds_read_b64_tr_b16 v[198:199], v242 offset:46080
    v_mfma_f32_16x16x32_bf16 v[232:235], v[200:203], v[88:91], v[232:235]
    s_waitcnt lgkmcnt(12)
    s_waitcnt vmcnt(48)
    ds_read_b64_tr_b16 v[200:201], v243 offset:45056
    v_mfma_f32_16x16x32_bf16 v[204:207], v[172:175], v[92:95], v[204:207]
    ds_read_b64_tr_b16 v[202:203], v243 offset:46080
    buffer_load_dwordx4 v[84:87], v244, s[16:19], s71 offen offset:2048 sc1
    v_mfma_f32_16x16x32_bf16 v[220:223], v[172:175], v[96:99], v[220:223]
    s_waitcnt lgkmcnt(12)
    ds_read_b64_tr_b16 v[172:173], v240 offset:49152
    v_mfma_f32_16x16x32_bf16 v[208:211], v[176:179], v[92:95], v[208:211]
    ds_read_b64_tr_b16 v[174:175], v240 offset:50176
    buffer_load_dwordx4 v[88:91], v244, s[16:19], s71 offen offset:2304 sc1
    s_add_u32 s78, s78, 4096
    s_and_b32 s78, s78, 0xffff
    s_add_u32 s71, s77, s78
    v_mfma_f32_16x16x32_bf16 v[224:227], v[176:179], v[96:99], v[224:227]
    s_waitcnt lgkmcnt(12)
    ds_read_b64_tr_b16 v[176:177], v241 offset:49152
    v_mfma_f32_16x16x32_bf16 v[212:215], v[180:183], v[92:95], v[212:215]
    ds_read_b64_tr_b16 v[178:179], v241 offset:50176
    v_mfma_f32_16x16x32_bf16 v[228:231], v[180:183], v[96:99], v[228:231]
    s_waitcnt lgkmcnt(12)
    ds_read_b64_tr_b16 v[180:181], v242 offset:49152
    v_mfma_f32_16x16x32_bf16 v[216:219], v[184:187], v[92:95], v[216:219]
    ds_read_b64_tr_b16 v[182:183], v242 offset:50176
    v_mfma_f32_16x16x32_bf16 v[232:235], v[184:187], v[96:99], v[232:235]
    s_waitcnt lgkmcnt(12)
    s_waitcnt vmcnt(48)
    ds_read_b64_tr_b16 v[184:185], v243 offset:49152
    v_mfma_f32_16x16x32_bf16 v[204:207], v[188:191], v[100:103], v[204:207]
    ds_read_b64_tr_b16 v[186:187], v243 offset:50176
    buffer_load_dwordx4 v[92:95], v244, s[16:19], s71 offen offset:0 sc1
    v_mfma_f32_16x16x32_bf16 v[220:223], v[188:191], v[104:107], v[220:223]
    s_waitcnt lgkmcnt(12)
    ds_read_b64_tr_b16 v[188:189], v240 offset:53248
    v_mfma_f32_16x16x32_bf16 v[208:211], v[192:195], v[100:103], v[208:211]
    ds_read_b64_tr_b16 v[190:191], v240 offset:54272
    buffer_load_dwordx4 v[96:99], v244, s[16:19], s71 offen offset:256 sc1
    v_mfma_f32_16x16x32_bf16 v[224:227], v[192:195], v[104:107], v[224:227]
    s_waitcnt lgkmcnt(12)
    ds_read_b64_tr_b16 v[192:193], v241 offset:53248
    v_mfma_f32_16x16x32_bf16 v[212:215], v[196:199], v[100:103], v[212:215]
    ds_read_b64_tr_b16 v[194:195], v241 offset:54272
    v_mfma_f32_16x16x32_bf16 v[228:231], v[196:199], v[104:107], v[228:231]
    s_waitcnt lgkmcnt(12)
    ds_read_b64_tr_b16 v[196:197], v242 offset:53248
    v_mfma_f32_16x16x32_bf16 v[216:219], v[200:203], v[100:103], v[216:219]
    ds_read_b64_tr_b16 v[198:199], v242 offset:54272
    v_mfma_f32_16x16x32_bf16 v[232:235], v[200:203], v[104:107], v[232:235]
    s_waitcnt lgkmcnt(12)
    s_waitcnt vmcnt(48)
    ds_read_b64_tr_b16 v[200:201], v243 offset:53248
    v_mfma_f32_16x16x32_bf16 v[204:207], v[172:175], v[108:111], v[204:207]
    ds_read_b64_tr_b16 v[202:203], v243 offset:54272
    buffer_load_dwordx4 v[100:103], v244, s[16:19], s71 offen offset:2048 sc1
    v_mfma_f32_16x16x32_bf16 v[220:223], v[172:175], v[112:115], v[220:223]
    s_waitcnt lgkmcnt(12)
    ds_read_b64_tr_b16 v[172:173], v240 offset:57344
    v_mfma_f32_16x16x32_bf16 v[208:211], v[176:179], v[108:111], v[208:211]
    ds_read_b64_tr_b16 v[174:175], v240 offset:58368
    buffer_load_dwordx4 v[104:107], v244, s[16:19], s71 offen offset:2304 sc1
    s_add_u32 s78, s78, 4096
    s_and_b32 s78, s78, 0xffff
    s_add_u32 s71, s77, s78
    v_mfma_f32_16x16x32_bf16 v[224:227], v[176:179], v[112:115], v[224:227]
    s_waitcnt lgkmcnt(12)
    ds_read_b64_tr_b16 v[176:177], v241 offset:57344
    v_mfma_f32_16x16x32_bf16 v[212:215], v[180:183], v[108:111], v[212:215]
    ds_read_b64_tr_b16 v[178:179], v241 offset:58368
    v_mfma_f32_16x16x32_bf16 v[228:231], v[180:183], v[112:115], v[228:231]
    s_waitcnt lgkmcnt(12)
    ds_read_b64_tr_b16 v[180:181], v242 offset:57344
    v_mfma_f32_16x16x32_bf16 v[216:219], v[184:187], v[108:111], v[216:219]
    ds_read_b64_tr_b16 v[182:183], v242 offset:58368
    v_mfma_f32_16x16x32_bf16 v[232:235], v[184:187], v[112:115], v[232:235]
    s_waitcnt lgkmcnt(12)
    s_waitcnt vmcnt(48)
    ds_read_b64_tr_b16 v[184:185], v243 offset:57344
    v_mfma_f32_16x16x32_bf16 v[204:207], v[188:191], v[116:119], v[204:207]
    ds_read_b64_tr_b16 v[186:187], v243 offset:58368
    v_mfma_f32_16x16x32_bf16 v[220:223], v[188:191], v[120:123], v[220:223]
    s_waitcnt lgkmcnt(12)
    ds_read_b64_tr_b16 v[188:189], v240 offset:61440
    v_mfma_f32_16x16x32_bf16 v[208:211], v[192:195], v[116:119], v[208:211]
    ds_read_b64_tr_b16 v[190:191], v240 offset:62464
    v_mfma_f32_16x16x32_bf16 v[224:227], v[192:195], v[120:123], v[224:227]
    s_waitcnt lgkmcnt(12)
    ds_read_b64_tr_b16 v[192:193], v241 offset:61440
    v_mfma_f32_16x16x32_bf16 v[212:215], v[196:199], v[116:119], v[212:215]
    ds_read_b64_tr_b16 v[194:195], v241 offset:62464
    v_mfma_f32_16x16x32_bf16 v[228:231], v[196:199], v[120:123], v[228:231]
    s_waitcnt lgkmcnt(12)
    ds_read_b64_tr_b16 v[196:197], v242 offset:61440
    v_mfma_f32_16x16x32_bf16 v[216:219], v[200:203], v[116:119], v[216:219]
    ds_read_b64_tr_b16 v[198:199], v242 offset:62464
    v_mfma_f32_16x16x32_bf16 v[232:235], v[200:203], v[120:123], v[232:235]
    s_waitcnt lgkmcnt(12)
    s_waitcnt vmcnt(46)
    ds_read_b64_tr_b16 v[200:201], v243 offset:61440
    v_mfma_f32_16x16x32_bf16 v[204:207], v[172:175], v[124:127], v[204:207]
    ds_read_b64_tr_b16 v[202:203], v243 offset:62464
    v_mfma_f32_16x16x32_bf16 v[220:223], v[172:175], v[128:131], v[220:223]
    v_add_u32 v240, s73, v240
    v_add_u32 v241, s73, v241
    v_add_u32 v242, s73, v242
    v_add_u32 v243, s73, v243
    s_waitcnt vmcnt(24)
    s_waitcnt lgkmcnt(0)
    s_barrier
    ds_read_b64_tr_b16 v[172:173], v240 offset:0
    v_mfma_f32_16x16x32_bf16 v[208:211], v[176:179], v[124:127], v[208:211]
    ds_read_b64_tr_b16 v[174:175], v240 offset:1024
    v_mfma_f32_16x16x32_bf16 v[224:227], v[176:179], v[128:131], v[224:227]
    ds_read_b64_tr_b16 v[176:177], v241 offset:0
    v_mfma_f32_16x16x32_bf16 v[212:215], v[180:183], v[124:127], v[212:215]
    ds_read_b64_tr_b16 v[178:179], v241 offset:1024
    v_mfma_f32_16x16x32_bf16 v[228:231], v[180:183], v[128:131], v[228:231]
    ds_read_b64_tr_b16 v[180:181], v242 offset:0
    v_mfma_f32_16x16x32_bf16 v[216:219], v[184:187], v[124:127], v[216:219]
    ds_read_b64_tr_b16 v[182:183], v242 offset:1024
    v_mfma_f32_16x16x32_bf16 v[232:235], v[184:187], v[128:131], v[232:235]
    ds_read_b64_tr_b16 v[184:185], v243 offset:0
    v_mfma_f32_16x16x32_bf16 v[204:207], v[188:191], v[132:135], v[204:207]
    ds_read_b64_tr_b16 v[186:187], v243 offset:1024
    v_mfma_f32_16x16x32_bf16 v[220:223], v[188:191], v[136:139], v[220:223]
    ds_read_b64_tr_b16 v[188:189], v240 offset:4096
    v_mfma_f32_16x16x32_bf16 v[208:211], v[192:195], v[132:135], v[208:211]
    ds_read_b64_tr_b16 v[190:191], v240 offset:5120
    v_mfma_f32_16x16x32_bf16 v[224:227], v[192:195], v[136:139], v[224:227]
    ds_read_b64_tr_b16 v[192:193], v241 offset:4096
    v_mfma_f32_16x16x32_bf16 v[212:215], v[196:199], v[132:135], v[212:215]
    ds_read_b64_tr_b16 v[194:195], v241 offset:5120
    v_mfma_f32_16x16x32_bf16 v[228:231], v[196:199], v[136:139], v[228:231]
    ds_read_b64_tr_b16 v[196:197], v242 offset:4096
    v_mfma_f32_16x16x32_bf16 v[216:219], v[200:203], v[132:135], v[216:219]
    ds_read_b64_tr_b16 v[198:199], v242 offset:5120
    v_mfma_f32_16x16x32_bf16 v[232:235], v[200:203], v[136:139], v[232:235]
    s_waitcnt lgkmcnt(12)
    ds_read_b64_tr_b16 v[200:201], v243 offset:4096
    v_mfma_f32_16x16x32_bf16 v[204:207], v[172:175], v[140:143], v[204:207]
    ds_read_b64_tr_b16 v[202:203], v243 offset:5120
    v_mfma_f32_16x16x32_bf16 v[220:223], v[172:175], v[144:147], v[220:223]
    s_waitcnt lgkmcnt(12)
    ds_read_b64_tr_b16 v[172:173], v240 offset:8192
    v_mfma_f32_16x16x32_bf16 v[208:211], v[176:179], v[140:143], v[208:211]
    ds_read_b64_tr_b16 v[174:175], v240 offset:9216
    v_mfma_f32_16x16x32_bf16 v[224:227], v[176:179], v[144:147], v[224:227]
    s_waitcnt lgkmcnt(12)
    ds_read_b64_tr_b16 v[176:177], v241 offset:8192
    v_mfma_f32_16x16x32_bf16 v[212:215], v[180:183], v[140:143], v[212:215]
    ds_read_b64_tr_b16 v[178:179], v241 offset:9216
    v_mfma_f32_16x16x32_bf16 v[228:231], v[180:183], v[144:147], v[228:231]
    s_waitcnt lgkmcnt(12)
    ds_read_b64_tr_b16 v[180:181], v242 offset:8192
    v_mfma_f32_16x16x32_bf16 v[216:219], v[184:187], v[140:143], v[216:219]
    ds_read_b64_tr_b16 v[182:183], v242 offset:9216
    v_mfma_f32_16x16x32_bf16 v[232:235], v[184:187], v[144:147], v[232:235]
    s_waitcnt lgkmcnt(12)
    ds_read_b64_tr_b16 v[184:185], v243 offset:8192
    v_mfma_f32_16x16x32_bf16 v[204:207], v[188:191], v[148:151], v[204:207]
    ds_read_b64_tr_b16 v[186:187], v243 offset:9216
    v_mfma_f32_16x16x32_bf16 v[220:223], v[188:191], v[152:155], v[220:223]
    s_waitcnt lgkmcnt(12)
    ds_read_b64_tr_b16 v[188:189], v240 offset:12288
    v_mfma_f32_16x16x32_bf16 v[208:211], v[192:195], v[148:151], v[208:211]
    ds_read_b64_tr_b16 v[190:191], v240 offset:13312
    v_mfma_f32_16x16x32_bf16 v[224:227], v[192:195], v[152:155], v[224:227]
    s_waitcnt lgkmcnt(12)
    ds_read_b64_tr_b16 v[192:193], v241 offset:12288
    v_mfma_f32_16x16x32_bf16 v[212:215], v[196:199], v[148:151], v[212:215]
    ds_read_b64_tr_b16 v[194:195], v241 offset:13312
    v_mfma_f32_16x16x32_bf16 v[228:231], v[196:199], v[152:155], v[228:231]
    s_waitcnt lgkmcnt(12)
    ds_read_b64_tr_b16 v[196:197], v242 offset:12288
    v_mfma_f32_16x16x32_bf16 v[216:219], v[200:203], v[148:151], v[216:219]
    ds_read_b64_tr_b16 v[198:199], v242 offset:13312
    v_mfma_f32_16x16x32_bf16 v[232:235], v[200:203], v[152:155], v[232:235]
    s_waitcnt lgkmcnt(12)
    ds_read_b64_tr_b16 v[200:201], v243 offset:12288
    v_mfma_f32_16x16x32_bf16 v[204:207], v[172:175], v[156:159], v[204:207]
    ds_read_b64_tr_b16 v[202:203], v243 offset:13312
    v_mfma_f32_16x16x32_bf16 v[220:223], v[172:175], v[160:163], v[220:223]
    s_waitcnt lgkmcnt(12)
    ds_read_b64_tr_b16 v[172:173], v240 offset:16384
    v_mfma_f32_16x16x32_bf16 v[208:211], v[176:179], v[156:159], v[208:211]
    ds_read_b64_tr_b16 v[174:175], v240 offset:17408
    v_mfma_f32_16x16x32_bf16 v[224:227], v[176:179], v[160:163], v[224:227]
    s_waitcnt lgkmcnt(12)
    ds_read_b64_tr_b16 v[176:177], v241 offset:16384
    v_mfma_f32_16x16x32_bf16 v[212:215], v[180:183], v[156:159], v[212:215]
    ds_read_b64_tr_b16 v[178:179], v241 offset:17408
    v_mfma_f32_16x16x32_bf16 v[228:231], v[180:183], v[160:163], v[228:231]
    s_waitcnt lgkmcnt(12)
    ds_read_b64_tr_b16 v[180:181], v242 offset:16384
    v_mfma_f32_16x16x32_bf16 v[216:219], v[184:187], v[156:159], v[216:219]
    ds_read_b64_tr_b16 v[182:183], v242 offset:17408
    v_mfma_f32_16x16x32_bf16 v[232:235], v[184:187], v[160:163], v[232:235]
    s_waitcnt lgkmcnt(12)
    ds_read_b64_tr_b16 v[184:185], v243 offset:16384
    v_mfma_f32_16x16x32_bf16 v[204:207], v[188:191], v[164:167], v[204:207]
    ds_read_b64_tr_b16 v[186:187], v243 offset:17408
    v_mfma_f32_16x16x32_bf16 v[220:223], v[188:191], v[168:171], v[220:223]
    s_waitcnt lgkmcnt(12)
    ds_read_b64_tr_b16 v[188:189], v240 offset:20480
    v_mfma_f32_16x16x32_bf16 v[208:211], v[192:195], v[164:167], v[208:211]
    ds_read_b64_tr_b16 v[190:191], v240 offset:21504
    v_mfma_f32_16x16x32_bf16 v[224:227], v[192:195], v[168:171], v[224:227]
    s_waitcnt lgkmcnt(12)
    ds_read_b64_tr_b16 v[192:193], v241 offset:20480
    v_mfma_f32_16x16x32_bf16 v[212:215], v[196:199], v[164:167], v[212:215]
    ds_read_b64_tr_b16 v[194:195], v241 offset:21504
    v_mfma_f32_16x16x32_bf16 v[228:231], v[196:199], v[168:171], v[228:231]
    s_waitcnt lgkmcnt(12)
    ds_read_b64_tr_b16 v[196:197], v242 offset:20480
    v_mfma_f32_16x16x32_bf16 v[216:219], v[200:203], v[164:167], v[216:219]
    ds_read_b64_tr_b16 v[198:199], v242 offset:21504
    v_mfma_f32_16x16x32_bf16 v[232:235], v[200:203], v[168:171], v[232:235]
    s_waitcnt lgkmcnt(12)
    s_waitcnt vmcnt(22)
    ds_read_b64_tr_b16 v[200:201], v243 offset:20480
    v_mfma_f32_16x16x32_bf16 v[204:207], v[172:175], v[12:15], v[204:207]
    ds_read_b64_tr_b16 v[202:203], v243 offset:21504
    v_mfma_f32_16x16x32_bf16 v[220:223], v[172:175], v[16:19], v[220:223]
    s_waitcnt lgkmcnt(12)
    ds_read_b64_tr_b16 v[172:173], v240 offset:24576
    v_mfma_f32_16x16x32_bf16 v[208:211], v[176:179], v[12:15], v[208:211]
    ds_read_b64_tr_b16 v[174:175], v240 offset:25600
    v_mfma_f32_16x16x32_bf16 v[224:227], v[176:179], v[16:19], v[224:227]
    s_waitcnt lgkmcnt(12)
    ds_read_b64_tr_b16 v[176:177], v241 offset:24576
    v_mfma_f32_16x16x32_bf16 v[212:215], v[180:183], v[12:15], v[212:215]
    ds_read_b64_tr_b16 v[178:179], v241 offset:25600
    v_mfma_f32_16x16x32_bf16 v[228:231], v[180:183], v[16:19], v[228:231]
    s_waitcnt lgkmcnt(12)
    ds_read_b64_tr_b16 v[180:181], v242 offset:24576
    v_mfma_f32_16x16x32_bf16 v[216:219], v[184:187], v[12:15], v[216:219]
    ds_read_b64_tr_b16 v[182:183], v242 offset:25600
    v_mfma_f32_16x16x32_bf16 v[232:235], v[184:187], v[16:19], v[232:235]
    s_waitcnt lgkmcnt(12)
    s_waitcnt vmcnt(20)
    ds_read_b64_tr_b16 v[184:185], v243 offset:24576
    v_mfma_f32_16x16x32_bf16 v[204:207], v[188:191], v[20:23], v[204:207]
    ds_read_b64_tr_b16 v[186:187], v243 offset:25600
    v_mfma_f32_16x16x32_bf16 v[220:223], v[188:191], v[24:27], v[220:223]
    s_waitcnt lgkmcnt(12)
    ds_read_b64_tr_b16 v[188:189], v240 offset:28672
    v_mfma_f32_16x16x32_bf16 v[208:211], v[192:195], v[20:23], v[208:211]
    ds_read_b64_tr_b16 v[190:191], v240 offset:29696
    v_mfma_f32_16x16x32_bf16 v[224:227], v[192:195], v[24:27], v[224:227]
    s_waitcnt lgkmcnt(12)
    ds_read_b64_tr_b16 v[192:193], v241 offset:28672
    v_mfma_f32_16x16x32_bf16 v[212:215], v[196:199], v[20:23], v[212:215]
    ds_read_b64_tr_b16 v[194:195], v241 offset:29696
    v_mfma_f32_16x16x32_bf16 v[228:231], v[196:199], v[24:27], v[228:231]
    s_waitcnt lgkmcnt(12)
    ds_read_b64_tr_b16 v[196:197], v242 offset:28672
    v_mfma_f32_16x16x32_bf16 v[216:219], v[200:203], v[20:23], v[216:219]
    ds_read_b64_tr_b16 v[198:199], v242 offset:29696
    v_mfma_f32_16x16x32_bf16 v[232:235], v[200:203], v[24:27], v[232:235]
    s_waitcnt lgkmcnt(12)
    s_waitcnt vmcnt(18)
    ds_read_b64_tr_b16 v[200:201], v243 offset:28672
    v_mfma_f32_16x16x32_bf16 v[204:207], v[172:175], v[28:31], v[204:207]
    ds_read_b64_tr_b16 v[202:203], v243 offset:29696
    v_mfma_f32_16x16x32_bf16 v[220:223], v[172:175], v[32:35], v[220:223]
    s_waitcnt lgkmcnt(12)
    ds_read_b64_tr_b16 v[172:173], v240 offset:32768
    v_mfma_f32_16x16x32_bf16 v[208:211], v[176:179], v[28:31], v[208:211]
    ds_read_b64_tr_b16 v[174:175], v240 offset:33792
    v_mfma_f32_16x16x32_bf16 v[224:227], v[176:179], v[32:35], v[224:227]
    s_waitcnt lgkmcnt(12)
    ds_read_b64_tr_b16 v[176:177], v241 offset:32768
    v_mfma_f32_16x16x32_bf16 v[212:215], v[180:183], v[28:31], v[212:215]
    ds_read_b64_tr_b16 v[178:179], v241 offset:33792
    v_mfma_f32_16x16x32_bf16 v[228:231], v[180:183], v[32:35], v[228:231]
    s_waitcnt lgkmcnt(12)
    ds_read_b64_tr_b16 v[180:181], v242 offset:32768
    v_mfma_f32_16x16x32_bf16 v[216:219], v[184:187], v[28:31], v[216:219]
    ds_read_b64_tr_b16 v[182:183], v242 offset:33792
    v_mfma_f32_16x16x32_bf16 v[232:235], v[184:187], v[32:35], v[232:235]
    s_waitcnt lgkmcnt(12)
    s_waitcnt vmcnt(16)
    ds_read_b64_tr_b16 v[184:185], v243 offset:32768
    v_mfma_f32_16x16x32_bf16 v[204:207], v[188:191], v[36:39], v[204:207]
    ds_read_b64_tr_b16 v[186:187], v243 offset:33792
    v_mfma_f32_16x16x32_bf16 v[220:223], v[188:191], v[40:43], v[220:223]
    s_waitcnt lgkmcnt(12)
    ds_read_b64_tr_b16 v[188:189], v240 offset:36864
    v_mfma_f32_16x16x32_bf16 v[208:211], v[192:195], v[36:39], v[208:211]
    ds_read_b64_tr_b16 v[190:191], v240 offset:37888
    v_mfma_f32_16x16x32_bf16 v[224:227], v[192:195], v[40:43], v[224:227]
    s_waitcnt lgkmcnt(12)
    ds_read_b64_tr_b16 v[192:193], v241 offset:36864
    v_mfma_f32_16x16x32_bf16 v[212:215], v[196:199], v[36:39], v[212:215]
    ds_read_b64_tr_b16 v[194:195], v241 offset:37888
    v_mfma_f32_16x16x32_bf16 v[228:231], v[196:199], v[40:43], v[228:231]
    s_waitcnt lgkmcnt(12)
    ds_read_b64_tr_b16 v[196:197], v242 offset:36864
    v_mfma_f32_16x16x32_bf16 v[216:219], v[200:203], v[36:39], v[216:219]
    ds_read_b64_tr_b16 v[198:199], v242 offset:37888
    v_mfma_f32_16x16x32_bf16 v[232:235], v[200:203], v[40:43], v[232:235]
    s_waitcnt lgkmcnt(12)
    s_waitcnt vmcnt(14)
    ds_read_b64_tr_b16 v[200:201], v243 offset:36864
    v_mfma_f32_16x16x32_bf16 v[204:207], v[172:175], v[44:47], v[204:207]
    ds_read_b64_tr_b16 v[202:203], v243 offset:37888
    v_mfma_f32_16x16x32_bf16 v[220:223], v[172:175], v[48:51], v[220:223]
    s_waitcnt lgkmcnt(12)
    ds_read_b64_tr_b16 v[172:173], v240 offset:40960
    v_mfma_f32_16x16x32_bf16 v[208:211], v[176:179], v[44:47], v[208:211]
    ds_read_b64_tr_b16 v[174:175], v240 offset:41984
    v_mfma_f32_16x16x32_bf16 v[224:227], v[176:179], v[48:51], v[224:227]
    s_waitcnt lgkmcnt(12)
    ds_read_b64_tr_b16 v[176:177], v241 offset:40960
    v_mfma_f32_16x16x32_bf16 v[212:215], v[180:183], v[44:47], v[212:215]
    ds_read_b64_tr_b16 v[178:179], v241 offset:41984
    v_mfma_f32_16x16x32_bf16 v[228:231], v[180:183], v[48:51], v[228:231]
    s_waitcnt lgkmcnt(12)
    ds_read_b64_tr_b16 v[180:181], v242 offset:40960
    v_mfma_f32_16x16x32_bf16 v[216:219], v[184:187], v[44:47], v[216:219]
    ds_read_b64_tr_b16 v[182:183], v242 offset:41984
    v_mfma_f32_16x16x32_bf16 v[232:235], v[184:187], v[48:51], v[232:235]
    s_waitcnt lgkmcnt(12)
    s_waitcnt vmcnt(12)
    ds_read_b64_tr_b16 v[184:185], v243 offset:40960
    v_mfma_f32_16x16x32_bf16 v[204:207], v[188:191], v[52:55], v[204:207]
    ds_read_b64_tr_b16 v[186:187], v243 offset:41984
    v_mfma_f32_16x16x32_bf16 v[220:223], v[188:191], v[56:59], v[220:223]
    s_waitcnt lgkmcnt(12)
    ds_read_b64_tr_b16 v[188:189], v240 offset:45056
    v_mfma_f32_16x16x32_bf16 v[208:211], v[192:195], v[52:55], v[208:211]
    ds_read_b64_tr_b16 v[190:191], v240 offset:46080
    v_mfma_f32_16x16x32_bf16 v[224:227], v[192:195], v[56:59], v[224:227]
    s_waitcnt lgkmcnt(12)
    ds_read_b64_tr_b16 v[192:193], v241 offset:45056
    v_mfma_f32_16x16x32_bf16 v[212:215], v[196:199], v[52:55], v[212:215]
    ds_read_b64_tr_b16 v[194:195], v241 offset:46080
    v_mfma_f32_16x16x32_bf16 v[228:231], v[196:199], v[56:59], v[228:231]
    s_waitcnt lgkmcnt(12)
    ds_read_b64_tr_b16 v[196:197], v242 offset:45056
    v_mfma_f32_16x16x32_bf16 v[216:219], v[200:203], v[52:55], v[216:219]
    ds_read_b64_tr_b16 v[198:199], v242 offset:46080
    v_mfma_f32_16x16x32_bf16 v[232:235], v[200:203], v[56:59], v[232:235]
    s_waitcnt lgkmcnt(12)
    s_waitcnt vmcnt(10)
    ds_read_b64_tr_b16 v[200:201], v243 offset:45056
    v_mfma_f32_16x16x32_bf16 v[204:207], v[172:175], v[60:63], v[204:207]
    ds_read_b64_tr_b16 v[202:203], v243 offset:46080
    v_mfma_f32_16x16x32_bf16 v[220:223], v[172:175], v[64:67], v[220:223]
    s_waitcnt lgkmcnt(12)
    ds_read_b64_tr_b16 v[172:173], v240 offset:49152
    v_mfma_f32_16x16x32_bf16 v[208:211], v[176:179], v[60:63], v[208:211]
    ds_read_b64_tr_b16 v[174:175], v240 offset:50176
    v_mfma_f32_16x16x32_bf16 v[224:227], v[176:179], v[64:67], v[224:227]
    s_waitcnt lgkmcnt(12)
    ds_read_b64_tr_b16 v[176:177], v241 offset:49152
    v_mfma_f32_16x16x32_bf16 v[212:215], v[180:183], v[60:63], v[212:215]
    ds_read_b64_tr_b16 v[178:179], v241 offset:50176
    v_mfma_f32_16x16x32_bf16 v[228:231], v[180:183], v[64:67], v[228:231]
    s_waitcnt lgkmcnt(12)
    ds_read_b64_tr_b16 v[180:181], v242 offset:49152
    v_mfma_f32_16x16x32_bf16 v[216:219], v[184:187], v[60:63], v[216:219]
    ds_read_b64_tr_b16 v[182:183], v242 offset:50176
    v_mfma_f32_16x16x32_bf16 v[232:235], v[184:187], v[64:67], v[232:235]
    s_waitcnt lgkmcnt(12)
    s_waitcnt vmcnt(8)
    ds_read_b64_tr_b16 v[184:185], v243 offset:49152
    v_mfma_f32_16x16x32_bf16 v[204:207], v[188:191], v[68:71], v[204:207]
    ds_read_b64_tr_b16 v[186:187], v243 offset:50176
    v_mfma_f32_16x16x32_bf16 v[220:223], v[188:191], v[72:75], v[220:223]
    s_waitcnt lgkmcnt(12)
    ds_read_b64_tr_b16 v[188:189], v240 offset:53248
    v_mfma_f32_16x16x32_bf16 v[208:211], v[192:195], v[68:71], v[208:211]
    ds_read_b64_tr_b16 v[190:191], v240 offset:54272
    v_mfma_f32_16x16x32_bf16 v[224:227], v[192:195], v[72:75], v[224:227]
    s_waitcnt lgkmcnt(12)
    ds_read_b64_tr_b16 v[192:193], v241 offset:53248
    v_mfma_f32_16x16x32_bf16 v[212:215], v[196:199], v[68:71], v[212:215]
    ds_read_b64_tr_b16 v[194:195], v241 offset:54272
    v_mfma_f32_16x16x32_bf16 v[228:231], v[196:199], v[72:75], v[228:231]
    s_waitcnt lgkmcnt(12)
    ds_read_b64_tr_b16 v[196:197], v242 offset:53248
    v_mfma_f32_16x16x32_bf16 v[216:219], v[200:203], v[68:71], v[216:219]
    ds_read_b64_tr_b16 v[198:199], v242 offset:54272
    v_mfma_f32_16x16x32_bf16 v[232:235], v[200:203], v[72:75], v[232:235]
    s_waitcnt lgkmcnt(12)
    s_waitcnt vmcnt(6)
    ds_read_b64_tr_b16 v[200:201], v243 offset:53248
    v_mfma_f32_16x16x32_bf16 v[204:207], v[172:175], v[76:79], v[204:207]
    ds_read_b64_tr_b16 v[202:203], v243 offset:54272
    v_mfma_f32_16x16x32_bf16 v[220:223], v[172:175], v[80:83], v[220:223]
    s_waitcnt lgkmcnt(12)
    ds_read_b64_tr_b16 v[172:173], v240 offset:57344
    v_mfma_f32_16x16x32_bf16 v[208:211], v[176:179], v[76:79], v[208:211]
    ds_read_b64_tr_b16 v[174:175], v240 offset:58368
    v_mfma_f32_16x16x32_bf16 v[224:227], v[176:179], v[80:83], v[224:227]
    s_waitcnt lgkmcnt(12)
    ds_read_b64_tr_b16 v[176:177], v241 offset:57344
    v_mfma_f32_16x16x32_bf16 v[212:215], v[180:183], v[76:79], v[212:215]
    ds_read_b64_tr_b16 v[178:179], v241 offset:58368
    v_mfma_f32_16x16x32_bf16 v[228:231], v[180:183], v[80:83], v[228:231]
    s_waitcnt lgkmcnt(12)
    ds_read_b64_tr_b16 v[180:181], v242 offset:57344
    v_mfma_f32_16x16x32_bf16 v[216:219], v[184:187], v[76:79], v[216:219]
    ds_read_b64_tr_b16 v[182:183], v242 offset:58368
    v_mfma_f32_16x16x32_bf16 v[232:235], v[184:187], v[80:83], v[232:235]
    s_waitcnt lgkmcnt(12)
    s_waitcnt vmcnt(4)
    ds_read_b64_tr_b16 v[184:185], v243 offset:57344
    v_mfma_f32_16x16x32_bf16 v[204:207], v[188:191], v[84:87], v[204:207]
    ds_read_b64_tr_b16 v[186:187], v243 offset:58368
    v_mfma_f32_16x16x32_bf16 v[220:223], v[188:191], v[88:91], v[220:223]
    s_waitcnt lgkmcnt(12)
    ds_read_b64_tr_b16 v[188:189], v240 offset:61440
    v_mfma_f32_16x16x32_bf16 v[208:211], v[192:195], v[84:87], v[208:211]
    ds_read_b64_tr_b16 v[190:191], v240 offset:62464
    v_mfma_f32_16x16x32_bf16 v[224:227], v[192:195], v[88:91], v[224:227]
    s_waitcnt lgkmcnt(12)
    ds_read_b64_tr_b16 v[192:193], v241 offset:61440
    v_mfma_f32_16x16x32_bf16 v[212:215], v[196:199], v[84:87], v[212:215]
    ds_read_b64_tr_b16 v[194:195], v241 offset:62464
    v_mfma_f32_16x16x32_bf16 v[228:231], v[196:199], v[88:91], v[228:231]
    s_waitcnt lgkmcnt(12)
    ds_read_b64_tr_b16 v[196:197], v242 offset:61440
    v_mfma_f32_16x16x32_bf16 v[216:219], v[200:203], v[84:87], v[216:219]
    ds_read_b64_tr_b16 v[198:199], v242 offset:62464
    v_mfma_f32_16x16x32_bf16 v[232:235], v[200:203], v[88:91], v[232:235]
    s_waitcnt lgkmcnt(12)
    s_waitcnt vmcnt(2)
    ds_read_b64_tr_b16 v[200:201], v243 offset:61440
    v_mfma_f32_16x16x32_bf16 v[204:207], v[172:175], v[92:95], v[204:207]
    ds_read_b64_tr_b16 v[202:203], v243 offset:62464
    v_mfma_f32_16x16x32_bf16 v[220:223], v[172:175], v[96:99], v[220:223]
    s_waitcnt lgkmcnt(0)
    s_barrier
    v_mfma_f32_16x16x32_bf16 v[208:211], v[176:179], v[92:95], v[208:211]
    v_mfma_f32_16x16x32_bf16 v[224:227], v[176:179], v[96:99], v[224:227]
    v_mfma_f32_16x16x32_bf16 v[212:215], v[180:183], v[92:95], v[212:215]
    v_mfma_f32_16x16x32_bf16 v[228:231], v[180:183], v[96:99], v[228:231]
    v_mfma_f32_16x16x32_bf16 v[216:219], v[184:187], v[92:95], v[216:219]
    v_mfma_f32_16x16x32_bf16 v[232:235], v[184:187], v[96:99], v[232:235]
    s_waitcnt vmcnt(0)
    v_mfma_f32_16x16x32_bf16 v[204:207], v[188:191], v[100:103], v[204:207]
    v_mfma_f32_16x16x32_bf16 v[220:223], v[188:191], v[104:107], v[220:223]
    v_mfma_f32_16x16x32_bf16 v[208:211], v[192:195], v[100:103], v[208:211]
    v_mfma_f32_16x16x32_bf16 v[224:227], v[192:195], v[104:107], v[224:227]
    v_mfma_f32_16x16x32_bf16 v[212:215], v[196:199], v[100:103], v[212:215]
    v_mfma_f32_16x16x32_bf16 v[228:231], v[196:199], v[104:107], v[228:231]
    v_mfma_f32_16x16x32_bf16 v[216:219], v[200:203], v[100:103], v[216:219]
    v_mfma_f32_16x16x32_bf16 v[232:235], v[200:203], v[104:107], v[232:235]
    s_branch K3_EPI
K1_COMPUTE:
    s_lshr_b32 s38, s22, 1
    s_and_b32 s39, s22, 1
    v_and_b32 v3, 31, v2
    v_lshrrev_b32 v4, 5, v2
    s_waitcnt lgkmcnt(0)
    s_mov_b32 s16, s60
    s_and_b32 s17, s61, 0xffff
    s_mov_b32 s18, 18259968
    s_mov_b32 s19, 0x20000
    s_mov_b32 s84, s58
    s_and_b32 s85, s59, 0xffff
    s_mov_b32 s86, 256
    s_mov_b32 s87, 0x20000
    s_cmp_eq_u32 s22, 0
    s_cbranch_scc0 K1_NW0
    v_and_b32 v10, 15, v2
    v_lshlrev_b32 v10, 2, v10
    v_add_u32 v10, 159744, v10
    v_mov_b32 v12, 0
    v_mov_b32 v13, 0
    ds_write_b32 v10, v12
    v_lshlrev_b32 v10, 7, v2
    s_cmp_eq_u32 s2, 255
    s_cbranch_scc1 K1_INIT
    s_bitcmp1_b32 s2, 0
    s_cselect_b64 s[62:63], s[52:53], s[50:51]
    s_mov_b32 s64, s62
    s_and_b32 s65, s63, 0xffff
    s_mov_b32 s66, 65536
    s_mov_b32 s67, 0x20000
    s_sub_u32 s27, s2, 128
    s_lshr_b32 s25, s27, 1
    s_lshl_b32 s25, s25, 13
    s_cmp_lt_u32 s27, 16
    s_cbranch_scc0 K1_WD
    buffer_load_dword v24, v10, s[64:67], s25 offen
    s_branch K1_WD
K1_INIT:
    s_mov_b32 s25, 18186240
    buffer_store_dwordx2 v[12:13], v10, s[16:19], s25 offen sc1
    s_add_u32 s25, s25, 8192
    buffer_store_dwordx2 v[12:13], v10, s[16:19], s25 offen sc1
    s_add_u32 s25, s25, 8192
    buffer_store_dwordx2 v[12:13], v10, s[16:19], s25 offen sc1
    s_add_u32 s25, s25, 8192
    buffer_store_dwordx2 v[12:13], v10, s[16:19], s25 offen sc1
    s_add_u32 s25, s25, 8192
    buffer_store_dwordx2 v[12:13], v10, s[16:19], s25 offen sc1
    s_add_u32 s25, s25, 8192
    buffer_store_dwordx2 v[12:13], v10, s[16:19], s25 offen sc1
    s_add_u32 s25, s25, 8192
    buffer_store_dwordx2 v[12:13], v10, s[16:19], s25 offen sc1
    s_add_u32 s25, s25, 8192
    buffer_store_dwordx2 v[12:13], v10, s[16:19], s25 offen sc1
    s_add_u32 s25, s25, 8192
    buffer_store_dwordx2 v[12:13], v10, s[16:19], s25 offen sc1
    s_add_u32 s25, s25, 8192
    v_mov_b32 v14, 1
    s_waitcnt vmcnt(0)
    buffer_store_dword v14, v12, s[84:87], 0 offen sc1
    s_branch K1_WD
K1_NW0:
    s_cmp_eq_u32 s22, 3
    s_cbranch_scc1 K1_W3
    s_cmp_le_u32 s22, 2
    s_cbranch_scc0 K1_WD
    s_and_b32 s25, s21, 3
    s_lshr_b32 s27, s2, 5
    s_lshl_b32 s27, s27, 3
    s_add_u32 s27, s27, s20
    s_cmp_lt_u32 s25, 2
    s_cbranch_scc0 PFW_17
    v_lshrrev_b32 v12, 1, v2
    v_lshlrev_b32 v10, 11, v12
    v_and_b32 v12, 1, v2
    v_lshl_add_u32 v10, v12, 7, v10
    s_lshl_b32 s82, s27, 16
    s_mov_b32 s83, 4194304
    s_mov_b32 s90, 0x3fffff
    s_cmp_eq_u32 s25, 1
    s_cselect_b64 s[62:63], s[46:47], s[40:41]
    s_mov_b32 s30, 4
    s_branch PFD_18
PFW_17:
    v_lshlrev_b32 v10, 7, v2
    s_mov_b32 s90, -1
    s_lshl_b32 s30, s27, 1
    s_add_u32 s30, s30, s25
    s_sub_u32 s30, s30, 2
    s_sub_u32 s31, s30, 96
    s_cmp_lt_u32 s30, 96
    s_cselect_b32 s82, s30, s31
    s_cselect_b64 s[62:63], s[42:43], s[48:49]
    s_cselect_b32 s30, 6, 2
    s_lshl_b32 s83, s30, 17
    s_lshl_b32 s82, s82, 13
PFD_18:
    s_mov_b32 s64, s62
    s_and_b32 s65, s63, 0xffff
    s_lshl_b32 s66, s30, 20
    s_mov_b32 s67, 0x20000
    s_cmp_eq_u32 s22, 2
    s_cselect_b32 s25, s83, 0
    s_add_u32 s82, s82, s25
    s_lshl_b32 s83, s83, 1
    s_andn2_b32 s31, s82, s90
    s_lshr_b32 s31, s31, 14
    s_and_b32 s30, s82, s90
    s_add_u32 s30, s30, s31
    buffer_load_dword v25, v10, s[64:67], s30 offen
    s_add_u32 s82, s82, s83
    s_branch K1_WD
K1_W3:
    s_getpc_b64 s[62:63]
K1_PC:
    s_sub_u32 s62, s62, K1_PC-concat_heads__linear_attn_block__grouped_kv_mqa__prompt_kernel
    s_subb_u32 s63, s63, 0
    s_cmp_lt_u32 s21, 27
    s_cbranch_scc1 K1_TLB
    s_sub_u32 s25, s21, 27
    s_lshl_b32 s25, s25, 13
    v_lshl_add_u32 v10, v2, 7, s25
    v_min_u32 v10, K2_SLOW-concat_heads__linear_attn_block__grouped_kv_mqa__prompt_kernel, v10
    global_load_dword v26, v10, s[62:63]
    s_branch K1_WD
K1_TLB:
K1_WD:
    s_add_u32 s25, s28, 13
    s_lshl_b32 s25, s38, s25
    v_and_b32 v3, 15, v2
    v_lshrrev_b32 v4, 4, v2
    v_bfe_u32 v5, v2, 1, 3
    v_lshl_add_u32 v6, v3, 7, s25
    v_xor_b32 v7, v4, v5
    v_lshl_add_u32 v16, v7, 4, v6
    v_xor_b32 v17, 64, v16
    v_bfe_u32 v5, v2, 2, 2
    v_lshl_add_u32 v6, v4, 3, v5
    v_bfe_u32 v7, v2, 4, 1
    v_bfe_u32 v8, v2, 1, 1
    v_lshl_add_u32 v7, v7, 1, v8
    v_and_b32 v8, 1, v2
    v_lshlrev_b32 v8, 3, v8
    v_lshl_add_u32 v8, v7, 4, v8
    v_lshl_add_u32 v22, v6, 6, v8
    v_xor_b32 v23, 32, v22
    v_lshl_add_u32 v8, v5, 6, v8
    v_lshl_add_u32 v8, v6, 8, v8
    s_lshl_b32 s25, s39, 7
    v_xor_b32 v18, s25, v8
    v_xor_b32 v19, 32, v18
    v_xor_b32 v20, 64, v18
    v_xor_b32 v21, 96, v18
    v_lshlrev_b32 v3, 4, v3
    v_lshl_add_u32 v31, v4, 9, v3
    s_mov_b32 s34, 0
    s_mov_b32 s35, 16
    v_lshlrev_b32 v3, 4, v2
    s_cmp_eq_u32 s28, 1
    s_cbranch_scc1 K1_Y
    v_mov_b32 v96, 0
    v_mov_b32 v97, 0
    v_mov_b32 v98, 0
    v_mov_b32 v99, 0
    v_mov_b32 v100, 0
    v_mov_b32 v101, 0
    v_mov_b32 v102, 0
    v_mov_b32 v103, 0
    v_mov_b32 v104, 0
    v_mov_b32 v105, 0
    v_mov_b32 v106, 0
    v_mov_b32 v107, 0
    v_mov_b32 v108, 0
    v_mov_b32 v109, 0
    v_mov_b32 v110, 0
    v_mov_b32 v111, 0
    v_mov_b32 v112, 0
    v_mov_b32 v113, 0
    v_mov_b32 v114, 0
    v_mov_b32 v115, 0
    v_mov_b32 v116, 0
    v_mov_b32 v117, 0
    v_mov_b32 v118, 0
    v_mov_b32 v119, 0
    v_mov_b32 v120, 0
    v_mov_b32 v121, 0
    v_mov_b32 v122, 0
    v_mov_b32 v123, 0
    v_mov_b32 v124, 0
    v_mov_b32 v125, 0
    v_mov_b32 v126, 0
    v_mov_b32 v127, 0
    v_mov_b32 v128, 0
    v_mov_b32 v129, 0
    v_mov_b32 v130, 0
    v_mov_b32 v131, 0
    v_mov_b32 v132, 0
    v_mov_b32 v133, 0
    v_mov_b32 v134, 0
    v_mov_b32 v135, 0
    v_mov_b32 v136, 0
    v_mov_b32 v137, 0
    v_mov_b32 v138, 0
    v_mov_b32 v139, 0
    v_mov_b32 v140, 0
    v_mov_b32 v141, 0
    v_mov_b32 v142, 0
    v_mov_b32 v143, 0
    v_mov_b32 v144, 0
    v_mov_b32 v145, 0
    v_mov_b32 v146, 0
    v_mov_b32 v147, 0
    v_mov_b32 v148, 0
    v_mov_b32 v149, 0
    v_mov_b32 v150, 0
    v_mov_b32 v151, 0
    v_mov_b32 v152, 0
    v_mov_b32 v153, 0
    v_mov_b32 v154, 0
    v_mov_b32 v155, 0
    v_mov_b32 v156, 0
    v_mov_b32 v157, 0
    v_mov_b32 v158, 0
    v_mov_b32 v159, 0
    v_mov_b32 v160, 0
    v_mov_b32 v161, 0
    v_mov_b32 v162, 0
    v_mov_b32 v163, 0
    v_mov_b32 v164, 0
    v_mov_b32 v165, 0
    v_mov_b32 v166, 0
    v_mov_b32 v167, 0
    v_mov_b32 v168, 0
    v_mov_b32 v169, 0
    v_mov_b32 v170, 0
    v_mov_b32 v171, 0
    v_mov_b32 v172, 0
    v_mov_b32 v173, 0
    v_mov_b32 v174, 0
    v_mov_b32 v175, 0
    s_mov_b32 s80, 36864
    s_lshl_b32 s27, s24, 1
    s_add_u32 s27, s27, s39
    s_lshl_b32 s74, s27, 8
    s_lshl_b32 s27, s27, 12
    s_add_u32 s27, s27, 4210688
    s_lshl_b32 s72, s23, 2
    s_add_u32 s73, s72, s33
    s_lshl_b32 s25, s38, 1
    s_add_u32 s25, s25, s33
    s_add_u32 s25, s25, 0
    s_and_b32 s25, s25, 3
    s_add_u32 s25, s25, s72
    s_mul_i32 s25, s25, 65792
    s_add_u32 s68, s25, s27
    s_lshl_b32 s25, s38, 1
    s_add_u32 s25, s25, s33
    s_add_u32 s25, s25, 1
    s_and_b32 s25, s25, 3
    s_add_u32 s25, s25, s72
    s_mul_i32 s25, s25, 65792
    s_add_u32 s69, s25, s27
    s_lshr_b32 s25, s23, 1
    s_lshl_b32 s25, s25, 12
    s_add_u32 s74, s74, s25
    s_add_u32 s74, s74, 18186240
    v_lshlrev_b32 v248, 7, v2
    s_mov_b64 s[92:93], 3
    s_mov_b32 s33, 0
    s_mov_b32 s32, 0
    v_mov_b32 v29, 0
    v_add_u32 v30, 147456, v3
    s_mov_b32 s27, 159760
    s_waitcnt lgkmcnt(0)
    s_cmp_eq_u32 s38, 1
    s_cbranch_scc1 K1_MLX
    s_cmp_eq_u32 s39, 1
    s_cbranch_scc1 K1_X1
    s_bitcmp1_b32 s24, 2
    s_cbranch_scc1 K1_MLV0
K1_MLK0:
    s_barrier
    ds_read_b128 v[32:35], v16 offset:0
    ds_read_b128 v[36:39], v16 offset:2048
    ds_read_b128 v[40:43], v16 offset:4096
    ds_read_b128 v[44:47], v16 offset:6144
    ds_read_b64_tr_b16 v[48:49], v18 offset:16384
    ds_read_b64_tr_b16 v[50:51], v18 offset:17408
    ds_read_b64_tr_b16 v[52:53], v19 offset:16384
    ds_read_b64_tr_b16 v[54:55], v19 offset:17408
    ds_read_b64_tr_b16 v[56:57], v20 offset:16384
    ds_read_b64_tr_b16 v[58:59], v20 offset:17408
    ds_read_b64_tr_b16 v[60:61], v21 offset:16384
    ds_read_b64_tr_b16 v[62:63], v21 offset:17408
    ds_read_b64_tr_b16 v[64:65], v22 offset:32768
    ds_read_b64_tr_b16 v[66:67], v22 offset:33024
    ds_read_b64_tr_b16 v[68:69], v23 offset:32768
    ds_read_b64_tr_b16 v[70:71], v23 offset:33024
    s_waitcnt lgkmcnt(0)
K1_LOOPK0:
    v_mfma_f32_16x16x32_bf16 v[112:115], v[48:51], v[32:35], v[112:115]
    ds_read_b64_tr_b16 v[192:193], v18 offset:24576
    s_add_u32 s34, s34, 1
    s_cmp_eq_u32 s34, 4
    v_mfma_f32_16x16x32_bf16 v[120:123], v[48:51], v[36:39], v[120:123]
    ds_read_b64_tr_b16 v[194:195], v18 offset:25600
    s_cselect_b32 s36, 4294856704, s80
    s_cselect_b32 s34, 0, s34
    v_mfma_f32_16x16x32_bf16 v[144:147], v[48:51], v[40:43], v[144:147]
    ds_read_b64_tr_b16 v[196:197], v19 offset:24576
    v_add_u32 v16, s36, v16
    v_mfma_f32_16x16x32_bf16 v[152:155], v[48:51], v[44:47], v[152:155]
    s_waitcnt lgkmcnt(11)
    ds_read_b64_tr_b16 v[198:199], v19 offset:25600
    v_add_u32 v22, s36, v22
    v_mfma_f32_16x16x32_bf16 v[116:119], v[52:55], v[32:35], v[116:119]
    ds_read_b64_tr_b16 v[200:201], v20 offset:24576
    v_add_u32 v23, s36, v23
    v_mfma_f32_16x16x32_bf16 v[124:127], v[52:55], v[36:39], v[124:127]
    ds_read_b64_tr_b16 v[202:203], v20 offset:25600
    v_mfma_f32_16x16x32_bf16 v[148:151], v[52:55], v[40:43], v[148:151]
    ds_read_b64_tr_b16 v[204:205], v21 offset:24576
    v_mfma_f32_16x16x32_bf16 v[156:159], v[52:55], v[44:47], v[156:159]
    s_waitcnt lgkmcnt(13)
    ds_read_b64_tr_b16 v[206:207], v21 offset:25600
    v_mfma_f32_16x16x32_bf16 v[128:131], v[56:59], v[32:35], v[128:131]
    ds_read_b128 v[176:179], v17 offset:0
    v_mfma_f32_16x16x32_bf16 v[136:139], v[56:59], v[36:39], v[136:139]
    ds_read_b128 v[180:183], v17 offset:2048
    v_add_u32 v18, s36, v18
    v_mfma_f32_16x16x32_bf16 v[160:163], v[56:59], v[40:43], v[160:163]
    ds_read_b128 v[184:187], v17 offset:4096
    v_add_u32 v19, s36, v19
    v_mfma_f32_16x16x32_bf16 v[168:171], v[56:59], v[44:47], v[168:171]
    s_waitcnt lgkmcnt(15)
    ds_read_b128 v[188:191], v17 offset:6144
    v_add_u32 v20, s36, v20
    v_mfma_f32_16x16x32_bf16 v[132:135], v[60:63], v[32:35], v[132:135]
    v_add_u32 v21, s36, v21
    v_mfma_f32_16x16x32_bf16 v[140:143], v[60:63], v[36:39], v[140:143]
    v_mfma_f32_16x16x32_bf16 v[164:167], v[60:63], v[40:43], v[164:167]
    v_mfma_f32_16x16x32_bf16 v[172:175], v[60:63], v[44:47], v[172:175]
    s_waitcnt lgkmcnt(14)
    v_mfma_f32_16x16x32_bf16 v[96:99], v[64:67], v[32:35], v[96:99]
    s_waitcnt lgkmcnt(12)
    v_mfma_f32_16x16x32_bf16 v[100:103], v[68:71], v[32:35], v[100:103]
    v_mfma_f32_16x16x32_bf16 v[104:107], v[64:67], v[36:39], v[104:107]
    v_mfma_f32_16x16x32_bf16 v[108:111], v[68:71], v[36:39], v[108:111]
    s_waitcnt lgkmcnt(3)
    v_mfma_f32_16x16x32_bf16 v[112:115], v[192:195], v[176:179], v[112:115]
    s_barrier
    ds_read_b128 v[32:35], v16 offset:0
    ds_read_b128 v[36:39], v16 offset:2048
    v_mfma_f32_16x16x32_bf16 v[116:119], v[196:199], v[176:179], v[116:119]
    ds_read_b128 v[40:43], v16 offset:4096
    ds_read_b128 v[44:47], v16 offset:6144
    v_add_u32 v17, s36, v17
    v_mfma_f32_16x16x32_bf16 v[128:131], v[200:203], v[176:179], v[128:131]
    ds_read_b64_tr_b16 v[48:49], v18 offset:16384
    ds_read_b64_tr_b16 v[50:51], v18 offset:17408
    v_mfma_f32_16x16x32_bf16 v[132:135], v[204:207], v[176:179], v[132:135]
    s_waitcnt lgkmcnt(8)
    ds_read_b64_tr_b16 v[52:53], v19 offset:16384
    v_mfma_f32_16x16x32_bf16 v[120:123], v[192:195], v[180:183], v[120:123]
    ds_read_b64_tr_b16 v[54:55], v19 offset:17408
    v_mfma_f32_16x16x32_bf16 v[124:127], v[196:199], v[180:183], v[124:127]
    ds_read_b64_tr_b16 v[56:57], v20 offset:16384
    v_mfma_f32_16x16x32_bf16 v[136:139], v[200:203], v[180:183], v[136:139]
    ds_read_b64_tr_b16 v[58:59], v20 offset:17408
    v_mfma_f32_16x16x32_bf16 v[140:143], v[204:207], v[180:183], v[140:143]
    s_waitcnt lgkmcnt(11)
    ds_read_b64_tr_b16 v[60:61], v21 offset:16384
    v_mfma_f32_16x16x32_bf16 v[144:147], v[192:195], v[184:187], v[144:147]
    ds_read_b64_tr_b16 v[62:63], v21 offset:17408
    v_mfma_f32_16x16x32_bf16 v[148:151], v[196:199], v[184:187], v[148:151]
    ds_read_b64_tr_b16 v[64:65], v22 offset:32768
    v_mfma_f32_16x16x32_bf16 v[160:163], v[200:203], v[184:187], v[160:163]
    ds_read_b64_tr_b16 v[66:67], v22 offset:33024
    v_mfma_f32_16x16x32_bf16 v[164:167], v[204:207], v[184:187], v[164:167]
    s_waitcnt lgkmcnt(14)
    ds_read_b64_tr_b16 v[68:69], v23 offset:32768
    v_mfma_f32_16x16x32_bf16 v[152:155], v[192:195], v[188:191], v[152:155]
    ds_read_b64_tr_b16 v[70:71], v23 offset:33024
    v_mfma_f32_16x16x32_bf16 v[156:159], v[196:199], v[188:191], v[156:159]
    s_sub_u32 s35, s35, 1
    s_cmp_lg_u32 s35, 0
    v_mfma_f32_16x16x32_bf16 v[168:171], v[200:203], v[188:191], v[168:171]
    v_mfma_f32_16x16x32_bf16 v[172:175], v[204:207], v[188:191], v[172:175]
    s_waitcnt lgkmcnt(10)
    s_cbranch_scc1 K1_LOOPK0
    s_mov_b32 s25, 16842752
    v_mov_b32 v4, 0x3e8293ee
    v_and_b32 v10, 8, v2
    v_lshl_add_u32 v10, v10, 4, v31
    v_add_u32 v11, 128, v10
    s_branch K1_EPX
K1_MLV0:
    s_barrier
    ds_read_b128 v[32:35], v16 offset:0
    ds_read_b128 v[36:39], v16 offset:2048
    ds_read_b128 v[40:43], v16 offset:4096
    ds_read_b128 v[44:47], v16 offset:6144
    ds_read_b64_tr_b16 v[48:49], v18 offset:16384
    ds_read_b64_tr_b16 v[50:51], v18 offset:17408
    ds_read_b64_tr_b16 v[52:53], v19 offset:16384
    ds_read_b64_tr_b16 v[54:55], v19 offset:17408
    ds_read_b64_tr_b16 v[56:57], v20 offset:16384
    ds_read_b64_tr_b16 v[58:59], v20 offset:17408
    ds_read_b64_tr_b16 v[60:61], v21 offset:16384
    ds_read_b64_tr_b16 v[62:63], v21 offset:17408
    ds_read_b64_tr_b16 v[64:65], v22 offset:32768
    ds_read_b64_tr_b16 v[66:67], v22 offset:33024
    ds_read_b64_tr_b16 v[68:69], v23 offset:32768
    ds_read_b64_tr_b16 v[70:71], v23 offset:33024
    s_waitcnt lgkmcnt(0)
K1_LOOPV0:
    v_mfma_f32_16x16x32_bf16 v[112:115], v[48:51], v[32:35], v[112:115]
    ds_read_b64_tr_b16 v[192:193], v18 offset:24576
    s_add_u32 s34, s34, 1
    s_cmp_eq_u32 s34, 4
    v_mfma_f32_16x16x32_bf16 v[120:123], v[48:51], v[36:39], v[120:123]
    ds_read_b64_tr_b16 v[194:195], v18 offset:25600
    s_cselect_b32 s36, 4294856704, s80
    s_cselect_b32 s34, 0, s34
    v_mfma_f32_16x16x32_bf16 v[144:147], v[48:51], v[40:43], v[144:147]
    ds_read_b64_tr_b16 v[196:197], v19 offset:24576
    v_add_u32 v16, s36, v16
    v_mfma_f32_16x16x32_bf16 v[152:155], v[48:51], v[44:47], v[152:155]
    s_waitcnt lgkmcnt(11)
    ds_read_b64_tr_b16 v[198:199], v19 offset:25600
    v_add_u32 v22, s36, v22
    v_mfma_f32_16x16x32_bf16 v[116:119], v[52:55], v[32:35], v[116:119]
    ds_read_b64_tr_b16 v[200:201], v20 offset:24576
    v_add_u32 v23, s36, v23
    v_mfma_f32_16x16x32_bf16 v[124:127], v[52:55], v[36:39], v[124:127]
    ds_read_b64_tr_b16 v[202:203], v20 offset:25600
    v_mfma_f32_16x16x32_bf16 v[148:151], v[52:55], v[40:43], v[148:151]
    ds_read_b64_tr_b16 v[204:205], v21 offset:24576
    v_mfma_f32_16x16x32_bf16 v[156:159], v[52:55], v[44:47], v[156:159]
    s_waitcnt lgkmcnt(13)
    ds_read_b64_tr_b16 v[206:207], v21 offset:25600
    v_mfma_f32_16x16x32_bf16 v[128:131], v[56:59], v[32:35], v[128:131]
    ds_read_b128 v[176:179], v17 offset:0
    v_mfma_f32_16x16x32_bf16 v[136:139], v[56:59], v[36:39], v[136:139]
    ds_read_b128 v[180:183], v17 offset:2048
    v_add_u32 v18, s36, v18
    v_mfma_f32_16x16x32_bf16 v[160:163], v[56:59], v[40:43], v[160:163]
    ds_read_b128 v[184:187], v17 offset:4096
    v_add_u32 v19, s36, v19
    v_mfma_f32_16x16x32_bf16 v[168:171], v[56:59], v[44:47], v[168:171]
    s_waitcnt lgkmcnt(15)
    ds_read_b128 v[188:191], v17 offset:6144
    v_add_u32 v20, s36, v20
    v_mfma_f32_16x16x32_bf16 v[132:135], v[60:63], v[32:35], v[132:135]
    v_add_u32 v21, s36, v21
    v_mfma_f32_16x16x32_bf16 v[140:143], v[60:63], v[36:39], v[140:143]
    v_mfma_f32_16x16x32_bf16 v[164:167], v[60:63], v[40:43], v[164:167]
    v_mfma_f32_16x16x32_bf16 v[172:175], v[60:63], v[44:47], v[172:175]
    s_waitcnt lgkmcnt(14)
    v_mfma_f32_16x16x32_bf16 v[96:99], v[32:35], v[64:67], v[96:99]
    s_waitcnt lgkmcnt(12)
    v_mfma_f32_16x16x32_bf16 v[104:107], v[32:35], v[68:71], v[104:107]
    v_mfma_f32_16x16x32_bf16 v[100:103], v[36:39], v[64:67], v[100:103]
    v_mfma_f32_16x16x32_bf16 v[108:111], v[36:39], v[68:71], v[108:111]
    s_waitcnt lgkmcnt(3)
    v_mfma_f32_16x16x32_bf16 v[112:115], v[192:195], v[176:179], v[112:115]
    s_barrier
    ds_read_b128 v[32:35], v16 offset:0
    ds_read_b128 v[36:39], v16 offset:2048
    v_mfma_f32_16x16x32_bf16 v[116:119], v[196:199], v[176:179], v[116:119]
    ds_read_b128 v[40:43], v16 offset:4096
    ds_read_b128 v[44:47], v16 offset:6144
    v_add_u32 v17, s36, v17
    v_mfma_f32_16x16x32_bf16 v[128:131], v[200:203], v[176:179], v[128:131]
    ds_read_b64_tr_b16 v[48:49], v18 offset:16384
    ds_read_b64_tr_b16 v[50:51], v18 offset:17408
    v_mfma_f32_16x16x32_bf16 v[132:135], v[204:207], v[176:179], v[132:135]
    s_waitcnt lgkmcnt(8)
    ds_read_b64_tr_b16 v[52:53], v19 offset:16384
    v_mfma_f32_16x16x32_bf16 v[120:123], v[192:195], v[180:183], v[120:123]
    ds_read_b64_tr_b16 v[54:55], v19 offset:17408
    v_mfma_f32_16x16x32_bf16 v[124:127], v[196:199], v[180:183], v[124:127]
    ds_read_b64_tr_b16 v[56:57], v20 offset:16384
    v_mfma_f32_16x16x32_bf16 v[136:139], v[200:203], v[180:183], v[136:139]
    ds_read_b64_tr_b16 v[58:59], v20 offset:17408
    v_mfma_f32_16x16x32_bf16 v[140:143], v[204:207], v[180:183], v[140:143]
    s_waitcnt lgkmcnt(11)
    ds_read_b64_tr_b16 v[60:61], v21 offset:16384
    v_mfma_f32_16x16x32_bf16 v[144:147], v[192:195], v[184:187], v[144:147]
    ds_read_b64_tr_b16 v[62:63], v21 offset:17408
    v_mfma_f32_16x16x32_bf16 v[148:151], v[196:199], v[184:187], v[148:151]
    ds_read_b64_tr_b16 v[64:65], v22 offset:32768
    v_mfma_f32_16x16x32_bf16 v[160:163], v[200:203], v[184:187], v[160:163]
    ds_read_b64_tr_b16 v[66:67], v22 offset:33024
    v_mfma_f32_16x16x32_bf16 v[164:167], v[204:207], v[184:187], v[164:167]
    s_waitcnt lgkmcnt(14)
    ds_read_b64_tr_b16 v[68:69], v23 offset:32768
    v_mfma_f32_16x16x32_bf16 v[152:155], v[192:195], v[188:191], v[152:155]
    ds_read_b64_tr_b16 v[70:71], v23 offset:33024
    v_mfma_f32_16x16x32_bf16 v[156:159], v[196:199], v[188:191], v[156:159]
    s_sub_u32 s35, s35, 1
    s_cmp_lg_u32 s35, 0
    v_mfma_f32_16x16x32_bf16 v[168:171], v[200:203], v[188:191], v[168:171]
    v_mfma_f32_16x16x32_bf16 v[172:175], v[204:207], v[188:191], v[172:175]
    s_waitcnt lgkmcnt(10)
    s_cbranch_scc1 K1_LOOPV0
    s_mov_b32 s25, 16844800
    v_mov_b32 v4, 1.0
    v_mov_b32 v10, v31
    v_add_u32 v11, 256, v10
K1_EPX:
    v_mov_b32 v5, v4
    s_lshl_b32 s73, s73, 12
    s_add_u32 s73, s73, s25
    s_mov_b32 s32, 1
    v_mov_b32 v8, s27
LFW_19:
    ds_read_b32 v9, v8
    s_waitcnt lgkmcnt(0)
    v_cmp_eq_u32 vcc, 0, v9
    s_nop 0
    s_cbranch_vccnz LFW_19
    ds_read_b128 v[176:179], v30 offset:0
    ds_read_b128 v[180:183], v30 offset:1024
    ds_read_b128 v[184:187], v30 offset:2048
    ds_read_b128 v[188:191], v30 offset:3072
    s_waitcnt lgkmcnt(0)
    v_pk_add_f32 v[96:97], v[96:97], v[176:177]
    v_pk_add_f32 v[98:99], v[98:99], v[178:179]
    v_pk_add_f32 v[100:101], v[100:101], v[180:181]
    v_pk_add_f32 v[102:103], v[102:103], v[182:183]
    v_pk_add_f32 v[104:105], v[104:105], v[184:185]
    v_pk_add_f32 v[106:107], v[106:107], v[186:187]
    v_pk_add_f32 v[108:109], v[108:109], v[188:189]
    v_pk_add_f32 v[110:111], v[110:111], v[190:191]
    v_pk_mul_f32 v[96:97], v[96:97], v[4:5]
    v_pk_mul_f32 v[98:99], v[98:99], v[4:5]
    v_pk_mul_f32 v[100:101], v[100:101], v[4:5]
    v_pk_mul_f32 v[102:103], v[102:103], v[4:5]
    v_pk_mul_f32 v[104:105], v[104:105], v[4:5]
    v_pk_mul_f32 v[106:107], v[106:107], v[4:5]
    v_pk_mul_f32 v[108:109], v[108:109], v[4:5]
    v_pk_mul_f32 v[110:111], v[110:111], v[4:5]
    v_cvt_pk_bf16_f32 v96, v96, v97
    v_cvt_pk_bf16_f32 v97, v98, v99
    v_cvt_pk_bf16_f32 v98, v100, v101
    v_cvt_pk_bf16_f32 v99, v102, v103
    v_cvt_pk_bf16_f32 v100, v104, v105
    v_cvt_pk_bf16_f32 v101, v106, v107
    v_cvt_pk_bf16_f32 v102, v108, v109
    v_cvt_pk_bf16_f32 v103, v110, v111
    buffer_store_dwordx4 v[96:99], v10, s[16:19], s73 offen sc1
    buffer_store_dwordx4 v[100:103], v11, s[16:19], s73 offen sc1
    s_branch K1_EPB
K1_X1:
    s_bitcmp1_b32 s24, 2
    s_cbranch_scc1 K1_MLV1
K1_MLK1:
    s_barrier
    ds_read_b128 v[32:35], v16 offset:0
    ds_read_b128 v[36:39], v16 offset:2048
    ds_read_b128 v[40:43], v16 offset:4096
    ds_read_b128 v[44:47], v16 offset:6144
    ds_read_b64_tr_b16 v[48:49], v18 offset:16384
    ds_read_b64_tr_b16 v[50:51], v18 offset:17408
    ds_read_b64_tr_b16 v[52:53], v19 offset:16384
    ds_read_b64_tr_b16 v[54:55], v19 offset:17408
    ds_read_b64_tr_b16 v[56:57], v20 offset:16384
    ds_read_b64_tr_b16 v[58:59], v20 offset:17408
    ds_read_b64_tr_b16 v[60:61], v21 offset:16384
    ds_read_b64_tr_b16 v[62:63], v21 offset:17408
    s_waitcnt lgkmcnt(0)
K1_LOOPK1:
    v_mfma_f32_16x16x32_bf16 v[112:115], v[48:51], v[32:35], v[112:115]
    ds_read_b64_tr_b16 v[192:193], v18 offset:24576
    ds_read_b64_tr_b16 v[194:195], v18 offset:25600
    s_add_u32 s34, s34, 1
    s_cmp_eq_u32 s34, 4
    v_mfma_f32_16x16x32_bf16 v[120:123], v[48:51], v[36:39], v[120:123]
    ds_read_b64_tr_b16 v[196:197], v19 offset:24576
    ds_read_b64_tr_b16 v[198:199], v19 offset:25600
    s_cselect_b32 s36, 4294856704, s80
    s_cselect_b32 s34, 0, s34
    v_mfma_f32_16x16x32_bf16 v[144:147], v[48:51], v[40:43], v[144:147]
    ds_read_b64_tr_b16 v[200:201], v20 offset:24576
    ds_read_b64_tr_b16 v[202:203], v20 offset:25600
    v_add_u32 v16, s36, v16
    v_mfma_f32_16x16x32_bf16 v[152:155], v[48:51], v[44:47], v[152:155]
    s_waitcnt lgkmcnt(10)
    ds_read_b64_tr_b16 v[204:205], v21 offset:24576
    v_mfma_f32_16x16x32_bf16 v[116:119], v[52:55], v[32:35], v[116:119]
    ds_read_b64_tr_b16 v[206:207], v21 offset:25600
    v_mfma_f32_16x16x32_bf16 v[124:127], v[52:55], v[36:39], v[124:127]
    ds_read_b128 v[176:179], v17 offset:0
    v_mfma_f32_16x16x32_bf16 v[148:151], v[52:55], v[40:43], v[148:151]
    ds_read_b128 v[180:183], v17 offset:2048
    v_mfma_f32_16x16x32_bf16 v[156:159], v[52:55], v[44:47], v[156:159]
    s_waitcnt lgkmcnt(12)
    ds_read_b128 v[184:187], v17 offset:4096
    v_mfma_f32_16x16x32_bf16 v[128:131], v[56:59], v[32:35], v[128:131]
    ds_read_b128 v[188:191], v17 offset:6144
    v_mfma_f32_16x16x32_bf16 v[136:139], v[56:59], v[36:39], v[136:139]
    ds_read_b64_tr_b16 v[208:209], v22 offset:34816
    v_add_u32 v18, s36, v18
    v_mfma_f32_16x16x32_bf16 v[160:163], v[56:59], v[40:43], v[160:163]
    ds_read_b64_tr_b16 v[210:211], v22 offset:35072
    v_add_u32 v19, s36, v19
    v_mfma_f32_16x16x32_bf16 v[168:171], v[56:59], v[44:47], v[168:171]
    s_waitcnt lgkmcnt(14)
    ds_read_b64_tr_b16 v[212:213], v23 offset:34816
    v_add_u32 v20, s36, v20
    v_mfma_f32_16x16x32_bf16 v[132:135], v[60:63], v[32:35], v[132:135]
    ds_read_b64_tr_b16 v[214:215], v23 offset:35072
    v_add_u32 v21, s36, v21
    v_mfma_f32_16x16x32_bf16 v[140:143], v[60:63], v[36:39], v[140:143]
    v_mfma_f32_16x16x32_bf16 v[164:167], v[60:63], v[40:43], v[164:167]
    v_mfma_f32_16x16x32_bf16 v[172:175], v[60:63], v[44:47], v[172:175]
    s_waitcnt lgkmcnt(7)
    v_mfma_f32_16x16x32_bf16 v[112:115], v[192:195], v[176:179], v[112:115]
    s_barrier
    ds_read_b128 v[32:35], v16 offset:0
    v_mfma_f32_16x16x32_bf16 v[116:119], v[196:199], v[176:179], v[116:119]
    ds_read_b128 v[36:39], v16 offset:2048
    v_add_u32 v17, s36, v17
    v_mfma_f32_16x16x32_bf16 v[128:131], v[200:203], v[176:179], v[128:131]
    ds_read_b128 v[40:43], v16 offset:4096
    v_add_u32 v22, s36, v22
    v_mfma_f32_16x16x32_bf16 v[132:135], v[204:207], v[176:179], v[132:135]
    s_waitcnt lgkmcnt(9)
    ds_read_b128 v[44:47], v16 offset:6144
    v_add_u32 v23, s36, v23
    v_mfma_f32_16x16x32_bf16 v[120:123], v[192:195], v[180:183], v[120:123]
    ds_read_b64_tr_b16 v[48:49], v18 offset:16384
    v_mfma_f32_16x16x32_bf16 v[124:127], v[196:199], v[180:183], v[124:127]
    ds_read_b64_tr_b16 v[50:51], v18 offset:17408
    v_mfma_f32_16x16x32_bf16 v[136:139], v[200:203], v[180:183], v[136:139]
    ds_read_b64_tr_b16 v[52:53], v19 offset:16384
    v_mfma_f32_16x16x32_bf16 v[140:143], v[204:207], v[180:183], v[140:143]
    s_waitcnt lgkmcnt(12)
    ds_read_b64_tr_b16 v[54:55], v19 offset:17408
    v_mfma_f32_16x16x32_bf16 v[144:147], v[192:195], v[184:187], v[144:147]
    ds_read_b64_tr_b16 v[56:57], v20 offset:16384
    v_mfma_f32_16x16x32_bf16 v[148:151], v[196:199], v[184:187], v[148:151]
    ds_read_b64_tr_b16 v[58:59], v20 offset:17408
    v_mfma_f32_16x16x32_bf16 v[160:163], v[200:203], v[184:187], v[160:163]
    ds_read_b64_tr_b16 v[60:61], v21 offset:16384
    v_mfma_f32_16x16x32_bf16 v[164:167], v[204:207], v[184:187], v[164:167]
    s_waitcnt lgkmcnt(15)
    ds_read_b64_tr_b16 v[62:63], v21 offset:17408
    v_mfma_f32_16x16x32_bf16 v[152:155], v[192:195], v[188:191], v[152:155]
    v_mfma_f32_16x16x32_bf16 v[156:159], v[196:199], v[188:191], v[156:159]
    s_sub_u32 s35, s35, 1
    s_cmp_lg_u32 s35, 0
    v_mfma_f32_16x16x32_bf16 v[168:171], v[200:203], v[188:191], v[168:171]
    v_mfma_f32_16x16x32_bf16 v[172:175], v[204:207], v[188:191], v[172:175]
    s_waitcnt lgkmcnt(14)
    v_mfma_f32_16x16x32_bf16 v[96:99], v[208:211], v[176:179], v[96:99]
    s_waitcnt lgkmcnt(12)
    v_mfma_f32_16x16x32_bf16 v[100:103], v[212:215], v[176:179], v[100:103]
    v_mfma_f32_16x16x32_bf16 v[104:107], v[208:211], v[180:183], v[104:107]
    v_mfma_f32_16x16x32_bf16 v[108:111], v[212:215], v[180:183], v[108:111]
    s_waitcnt lgkmcnt(6)
    s_cbranch_scc1 K1_LOOPK1
    s_branch K1_EPX1
K1_MLV1:
    s_barrier
    ds_read_b128 v[32:35], v16 offset:0
    ds_read_b128 v[36:39], v16 offset:2048
    ds_read_b128 v[40:43], v16 offset:4096
    ds_read_b128 v[44:47], v16 offset:6144
    ds_read_b64_tr_b16 v[48:49], v18 offset:16384
    ds_read_b64_tr_b16 v[50:51], v18 offset:17408
    ds_read_b64_tr_b16 v[52:53], v19 offset:16384
    ds_read_b64_tr_b16 v[54:55], v19 offset:17408
    ds_read_b64_tr_b16 v[56:57], v20 offset:16384
    ds_read_b64_tr_b16 v[58:59], v20 offset:17408
    ds_read_b64_tr_b16 v[60:61], v21 offset:16384
    ds_read_b64_tr_b16 v[62:63], v21 offset:17408
    s_waitcnt lgkmcnt(0)
K1_LOOPV1:
    v_mfma_f32_16x16x32_bf16 v[112:115], v[48:51], v[32:35], v[112:115]
    ds_read_b64_tr_b16 v[192:193], v18 offset:24576
    ds_read_b64_tr_b16 v[194:195], v18 offset:25600
    s_add_u32 s34, s34, 1
    s_cmp_eq_u32 s34, 4
    v_mfma_f32_16x16x32_bf16 v[120:123], v[48:51], v[36:39], v[120:123]
    ds_read_b64_tr_b16 v[196:197], v19 offset:24576
    ds_read_b64_tr_b16 v[198:199], v19 offset:25600
    s_cselect_b32 s36, 4294856704, s80
    s_cselect_b32 s34, 0, s34
    v_mfma_f32_16x16x32_bf16 v[144:147], v[48:51], v[40:43], v[144:147]
    ds_read_b64_tr_b16 v[200:201], v20 offset:24576
    ds_read_b64_tr_b16 v[202:203], v20 offset:25600
    v_add_u32 v16, s36, v16
    v_mfma_f32_16x16x32_bf16 v[152:155], v[48:51], v[44:47], v[152:155]
    s_waitcnt lgkmcnt(10)
    ds_read_b64_tr_b16 v[204:205], v21 offset:24576
    v_mfma_f32_16x16x32_bf16 v[116:119], v[52:55], v[32:35], v[116:119]
    ds_read_b64_tr_b16 v[206:207], v21 offset:25600
    v_mfma_f32_16x16x32_bf16 v[124:127], v[52:55], v[36:39], v[124:127]
    ds_read_b128 v[176:179], v17 offset:0
    v_mfma_f32_16x16x32_bf16 v[148:151], v[52:55], v[40:43], v[148:151]
    ds_read_b128 v[180:183], v17 offset:2048
    v_mfma_f32_16x16x32_bf16 v[156:159], v[52:55], v[44:47], v[156:159]
    s_waitcnt lgkmcnt(12)
    ds_read_b128 v[184:187], v17 offset:4096
    v_mfma_f32_16x16x32_bf16 v[128:131], v[56:59], v[32:35], v[128:131]
    ds_read_b128 v[188:191], v17 offset:6144
    v_mfma_f32_16x16x32_bf16 v[136:139], v[56:59], v[36:39], v[136:139]
    ds_read_b64_tr_b16 v[208:209], v22 offset:34816
    v_add_u32 v18, s36, v18
    v_mfma_f32_16x16x32_bf16 v[160:163], v[56:59], v[40:43], v[160:163]
    ds_read_b64_tr_b16 v[210:211], v22 offset:35072
    v_add_u32 v19, s36, v19
    v_mfma_f32_16x16x32_bf16 v[168:171], v[56:59], v[44:47], v[168:171]
    s_waitcnt lgkmcnt(14)
    ds_read_b64_tr_b16 v[212:213], v23 offset:34816
    v_add_u32 v20, s36, v20
    v_mfma_f32_16x16x32_bf16 v[132:135], v[60:63], v[32:35], v[132:135]
    ds_read_b64_tr_b16 v[214:215], v23 offset:35072
    v_add_u32 v21, s36, v21
    v_mfma_f32_16x16x32_bf16 v[140:143], v[60:63], v[36:39], v[140:143]
    v_mfma_f32_16x16x32_bf16 v[164:167], v[60:63], v[40:43], v[164:167]
    v_mfma_f32_16x16x32_bf16 v[172:175], v[60:63], v[44:47], v[172:175]
    s_waitcnt lgkmcnt(7)
    v_mfma_f32_16x16x32_bf16 v[112:115], v[192:195], v[176:179], v[112:115]
    s_barrier
    ds_read_b128 v[32:35], v16 offset:0
    v_mfma_f32_16x16x32_bf16 v[116:119], v[196:199], v[176:179], v[116:119]
    ds_read_b128 v[36:39], v16 offset:2048
    v_add_u32 v17, s36, v17
    v_mfma_f32_16x16x32_bf16 v[128:131], v[200:203], v[176:179], v[128:131]
    ds_read_b128 v[40:43], v16 offset:4096
    v_add_u32 v22, s36, v22
    v_mfma_f32_16x16x32_bf16 v[132:135], v[204:207], v[176:179], v[132:135]
    s_waitcnt lgkmcnt(9)
    ds_read_b128 v[44:47], v16 offset:6144
    v_add_u32 v23, s36, v23
    v_mfma_f32_16x16x32_bf16 v[120:123], v[192:195], v[180:183], v[120:123]
    ds_read_b64_tr_b16 v[48:49], v18 offset:16384
    v_mfma_f32_16x16x32_bf16 v[124:127], v[196:199], v[180:183], v[124:127]
    ds_read_b64_tr_b16 v[50:51], v18 offset:17408
    v_mfma_f32_16x16x32_bf16 v[136:139], v[200:203], v[180:183], v[136:139]
    ds_read_b64_tr_b16 v[52:53], v19 offset:16384
    v_mfma_f32_16x16x32_bf16 v[140:143], v[204:207], v[180:183], v[140:143]
    s_waitcnt lgkmcnt(12)
    ds_read_b64_tr_b16 v[54:55], v19 offset:17408
    v_mfma_f32_16x16x32_bf16 v[144:147], v[192:195], v[184:187], v[144:147]
    ds_read_b64_tr_b16 v[56:57], v20 offset:16384
    v_mfma_f32_16x16x32_bf16 v[148:151], v[196:199], v[184:187], v[148:151]
    ds_read_b64_tr_b16 v[58:59], v20 offset:17408
    v_mfma_f32_16x16x32_bf16 v[160:163], v[200:203], v[184:187], v[160:163]
    ds_read_b64_tr_b16 v[60:61], v21 offset:16384
    v_mfma_f32_16x16x32_bf16 v[164:167], v[204:207], v[184:187], v[164:167]
    s_waitcnt lgkmcnt(15)
    ds_read_b64_tr_b16 v[62:63], v21 offset:17408
    v_mfma_f32_16x16x32_bf16 v[152:155], v[192:195], v[188:191], v[152:155]
    v_mfma_f32_16x16x32_bf16 v[156:159], v[196:199], v[188:191], v[156:159]
    s_sub_u32 s35, s35, 1
    s_cmp_lg_u32 s35, 0
    v_mfma_f32_16x16x32_bf16 v[168:171], v[200:203], v[188:191], v[168:171]
    v_mfma_f32_16x16x32_bf16 v[172:175], v[204:207], v[188:191], v[172:175]
    s_waitcnt lgkmcnt(14)
    v_mfma_f32_16x16x32_bf16 v[96:99], v[176:179], v[208:211], v[96:99]
    s_waitcnt lgkmcnt(12)
    v_mfma_f32_16x16x32_bf16 v[104:107], v[176:179], v[212:215], v[104:107]
    v_mfma_f32_16x16x32_bf16 v[100:103], v[180:183], v[208:211], v[100:103]
    v_mfma_f32_16x16x32_bf16 v[108:111], v[180:183], v[212:215], v[108:111]
    s_waitcnt lgkmcnt(6)
    s_cbranch_scc1 K1_LOOPV1
K1_EPX1:
    s_nop 11
    ds_write_b128 v30, v[96:99] offset:0
    ds_write_b128 v30, v[100:103] offset:1024
    ds_write_b128 v30, v[104:107] offset:2048
    ds_write_b128 v30, v[108:111] offset:3072
    v_mov_b32 v8, s27
    v_mov_b32 v9, 1
    s_waitcnt lgkmcnt(0)
    ds_write_b32 v8, v9
    s_branch K1_EPB
K1_MLX:
    s_barrier
    ds_read_b128 v[32:35], v16 offset:0
    ds_read_b128 v[36:39], v16 offset:2048
    ds_read_b128 v[40:43], v16 offset:4096
    ds_read_b128 v[44:47], v16 offset:6144
    ds_read_b64_tr_b16 v[48:49], v18 offset:16384
    ds_read_b64_tr_b16 v[50:51], v18 offset:17408
    ds_read_b64_tr_b16 v[52:53], v19 offset:16384
    ds_read_b64_tr_b16 v[54:55], v19 offset:17408
    ds_read_b64_tr_b16 v[56:57], v20 offset:16384
    ds_read_b64_tr_b16 v[58:59], v20 offset:17408
    ds_read_b64_tr_b16 v[60:61], v21 offset:16384
    ds_read_b64_tr_b16 v[62:63], v21 offset:17408
    s_waitcnt lgkmcnt(0)
K1_LOOPX:
    v_mfma_f32_16x16x32_bf16 v[112:115], v[48:51], v[32:35], v[112:115]
    ds_read_b64_tr_b16 v[192:193], v18 offset:24576
    s_add_u32 s34, s34, 1
    s_cmp_eq_u32 s34, 4
    v_mfma_f32_16x16x32_bf16 v[120:123], v[48:51], v[36:39], v[120:123]
    ds_read_b64_tr_b16 v[194:195], v18 offset:25600
    s_cselect_b32 s36, 4294856704, s80
    s_cselect_b32 s34, 0, s34
    v_mfma_f32_16x16x32_bf16 v[144:147], v[48:51], v[40:43], v[144:147]
    ds_read_b64_tr_b16 v[196:197], v19 offset:24576
    v_add_u32 v16, s36, v16
    v_mfma_f32_16x16x32_bf16 v[152:155], v[48:51], v[44:47], v[152:155]
    s_waitcnt lgkmcnt(7)
    ds_read_b64_tr_b16 v[198:199], v19 offset:25600
    v_mfma_f32_16x16x32_bf16 v[116:119], v[52:55], v[32:35], v[116:119]
    ds_read_b64_tr_b16 v[200:201], v20 offset:24576
    v_mfma_f32_16x16x32_bf16 v[124:127], v[52:55], v[36:39], v[124:127]
    ds_read_b64_tr_b16 v[202:203], v20 offset:25600
    v_mfma_f32_16x16x32_bf16 v[148:151], v[52:55], v[40:43], v[148:151]
    ds_read_b64_tr_b16 v[204:205], v21 offset:24576
    v_mfma_f32_16x16x32_bf16 v[156:159], v[52:55], v[44:47], v[156:159]
    s_waitcnt lgkmcnt(9)
    ds_read_b64_tr_b16 v[206:207], v21 offset:25600
    v_mfma_f32_16x16x32_bf16 v[128:131], v[56:59], v[32:35], v[128:131]
    ds_read_b128 v[176:179], v17 offset:0
    v_mfma_f32_16x16x32_bf16 v[136:139], v[56:59], v[36:39], v[136:139]
    ds_read_b128 v[180:183], v17 offset:2048
    v_add_u32 v18, s36, v18
    v_mfma_f32_16x16x32_bf16 v[160:163], v[56:59], v[40:43], v[160:163]
    ds_read_b128 v[184:187], v17 offset:4096
    v_add_u32 v19, s36, v19
    v_mfma_f32_16x16x32_bf16 v[168:171], v[56:59], v[44:47], v[168:171]
    s_waitcnt lgkmcnt(11)
    ds_read_b128 v[188:191], v17 offset:6144
    v_add_u32 v20, s36, v20
    v_mfma_f32_16x16x32_bf16 v[132:135], v[60:63], v[32:35], v[132:135]
    v_add_u32 v21, s36, v21
    v_mfma_f32_16x16x32_bf16 v[140:143], v[60:63], v[36:39], v[140:143]
    v_mfma_f32_16x16x32_bf16 v[164:167], v[60:63], v[40:43], v[164:167]
    v_mfma_f32_16x16x32_bf16 v[172:175], v[60:63], v[44:47], v[172:175]
    s_waitcnt lgkmcnt(3)
    v_mfma_f32_16x16x32_bf16 v[112:115], v[192:195], v[176:179], v[112:115]
    s_barrier
    ds_read_b128 v[32:35], v16 offset:0
    v_mfma_f32_16x16x32_bf16 v[116:119], v[196:199], v[176:179], v[116:119]
    ds_read_b128 v[36:39], v16 offset:2048
    v_add_u32 v17, s36, v17
    v_mfma_f32_16x16x32_bf16 v[128:131], v[200:203], v[176:179], v[128:131]
    ds_read_b128 v[40:43], v16 offset:4096
    v_mfma_f32_16x16x32_bf16 v[132:135], v[204:207], v[176:179], v[132:135]
    s_waitcnt lgkmcnt(5)
    ds_read_b128 v[44:47], v16 offset:6144
    v_mfma_f32_16x16x32_bf16 v[120:123], v[192:195], v[180:183], v[120:123]
    ds_read_b64_tr_b16 v[48:49], v18 offset:16384
    v_mfma_f32_16x16x32_bf16 v[124:127], v[196:199], v[180:183], v[124:127]
    ds_read_b64_tr_b16 v[50:51], v18 offset:17408
    v_mfma_f32_16x16x32_bf16 v[136:139], v[200:203], v[180:183], v[136:139]
    ds_read_b64_tr_b16 v[52:53], v19 offset:16384
    v_mfma_f32_16x16x32_bf16 v[140:143], v[204:207], v[180:183], v[140:143]
    s_waitcnt lgkmcnt(8)
    ds_read_b64_tr_b16 v[54:55], v19 offset:17408
    v_mfma_f32_16x16x32_bf16 v[144:147], v[192:195], v[184:187], v[144:147]
    ds_read_b64_tr_b16 v[56:57], v20 offset:16384
    v_mfma_f32_16x16x32_bf16 v[148:151], v[196:199], v[184:187], v[148:151]
    ds_read_b64_tr_b16 v[58:59], v20 offset:17408
    v_mfma_f32_16x16x32_bf16 v[160:163], v[200:203], v[184:187], v[160:163]
    ds_read_b64_tr_b16 v[60:61], v21 offset:16384
    v_mfma_f32_16x16x32_bf16 v[164:167], v[204:207], v[184:187], v[164:167]
    s_waitcnt lgkmcnt(11)
    ds_read_b64_tr_b16 v[62:63], v21 offset:17408
    v_mfma_f32_16x16x32_bf16 v[152:155], v[192:195], v[188:191], v[152:155]
    v_mfma_f32_16x16x32_bf16 v[156:159], v[196:199], v[188:191], v[156:159]
    s_sub_u32 s35, s35, 1
    s_cmp_lg_u32 s35, 0
    v_mfma_f32_16x16x32_bf16 v[168:171], v[200:203], v[188:191], v[168:171]
    v_mfma_f32_16x16x32_bf16 v[172:175], v[204:207], v[188:191], v[172:175]
    s_waitcnt lgkmcnt(6)
    s_cbranch_scc1 K1_LOOPX
    s_cmp_eq_u32 s33, 1
    s_cbranch_scc1 K1_XDEF
    s_cmp_eq_u32 s33, 2
    s_cbranch_scc1 K1_EPA
    s_nop 7
K1_EPB:
    s_mov_b32 s25, 0x358637bd
    v_cvt_pk_bf16_f32 v216, v112, v113
    v_cvt_pk_bf16_f32 v217, v114, v115
    v_cvt_pk_bf16_f32 v218, v116, v117
    v_cvt_pk_bf16_f32 v219, v118, v119
    v_cvt_pk_bf16_f32 v220, v120, v121
    v_cvt_pk_bf16_f32 v221, v122, v123
    v_cvt_pk_bf16_f32 v222, v124, v125
    v_cvt_pk_bf16_f32 v223, v126, v127
    buffer_store_dwordx4 v[216:219], v31, s[16:19], s68 offen offset:0 sc1
    buffer_store_dwordx4 v[220:223], v31, s[16:19], s68 offen offset:256 sc1
    v_cvt_pk_bf16_f32 v224, v128, v129
    v_cvt_pk_bf16_f32 v225, v130, v131
    v_cvt_pk_bf16_f32 v226, v132, v133
    v_cvt_pk_bf16_f32 v227, v134, v135
    v_cvt_pk_bf16_f32 v228, v136, v137
    v_cvt_pk_bf16_f32 v229, v138, v139
    v_cvt_pk_bf16_f32 v230, v140, v141
    v_cvt_pk_bf16_f32 v231, v142, v143
    buffer_store_dwordx4 v[224:227], v31, s[16:19], s68 offen offset:2048 sc1
    buffer_store_dwordx4 v[228:231], v31, s[16:19], s68 offen offset:2304 sc1
    v_cvt_pk_bf16_f32 v232, v144, v145
    v_cvt_pk_bf16_f32 v233, v146, v147
    v_cvt_pk_bf16_f32 v234, v148, v149
    v_cvt_pk_bf16_f32 v235, v150, v151
    v_cvt_pk_bf16_f32 v236, v152, v153
    v_cvt_pk_bf16_f32 v237, v154, v155
    v_cvt_pk_bf16_f32 v238, v156, v157
    v_cvt_pk_bf16_f32 v239, v158, v159
    buffer_store_dwordx4 v[232:235], v31, s[16:19], s69 offen offset:0 sc1
    buffer_store_dwordx4 v[236:239], v31, s[16:19], s69 offen offset:256 sc1
    v_cvt_pk_bf16_f32 v240, v160, v161
    v_cvt_pk_bf16_f32 v241, v162, v163
    v_cvt_pk_bf16_f32 v242, v164, v165
    v_cvt_pk_bf16_f32 v243, v166, v167
    v_cvt_pk_bf16_f32 v244, v168, v169
    v_cvt_pk_bf16_f32 v245, v170, v171
    v_cvt_pk_bf16_f32 v246, v172, v173
    v_cvt_pk_bf16_f32 v247, v174, v175
    buffer_store_dwordx4 v[240:243], v31, s[16:19], s69 offen offset:2048 sc1
    buffer_store_dwordx4 v[244:247], v31, s[16:19], s69 offen offset:2304 sc1
    buffer_load_dword v28, v29, s[84:87], 0 offen sc1
    v_mov_b32 v112, s25
    v_mov_b32 v113, s25
    v_mov_b32 v114, s25
    v_mov_b32 v115, s25
    v_mov_b32 v116, s25
    v_mov_b32 v117, s25
    v_mov_b32 v118, s25
    v_mov_b32 v119, s25
    v_mov_b32 v120, s25
    v_mov_b32 v121, s25
    v_mov_b32 v122, s25
    v_mov_b32 v123, s25
    v_mov_b32 v124, s25
    v_mov_b32 v125, s25
    v_mov_b32 v126, s25
    v_mov_b32 v127, s25
    v_mov_b32 v128, s25
    v_mov_b32 v129, s25
    v_mov_b32 v130, s25
    v_mov_b32 v131, s25
    v_mov_b32 v132, s25
    v_mov_b32 v133, s25
    v_mov_b32 v134, s25
    v_mov_b32 v135, s25
    v_mov_b32 v136, s25
    v_mov_b32 v137, s25
    v_mov_b32 v138, s25
    v_mov_b32 v139, s25
    v_mov_b32 v140, s25
    v_mov_b32 v141, s25
    v_mov_b32 v142, s25
    v_mov_b32 v143, s25
    v_mov_b32 v144, s25
    v_mov_b32 v145, s25
    v_mov_b32 v146, s25
    v_mov_b32 v147, s25
    v_mov_b32 v148, s25
    v_mov_b32 v149, s25
    v_mov_b32 v150, s25
    v_mov_b32 v151, s25
    v_mov_b32 v152, s25
    v_mov_b32 v153, s25
    v_mov_b32 v154, s25
    v_mov_b32 v155, s25
    v_mov_b32 v156, s25
    v_mov_b32 v157, s25
    v_mov_b32 v158, s25
    v_mov_b32 v159, s25
    v_mov_b32 v160, s25
    v_mov_b32 v161, s25
    v_mov_b32 v162, s25
    v_mov_b32 v163, s25
    v_mov_b32 v164, s25
    v_mov_b32 v165, s25
    v_mov_b32 v166, s25
    v_mov_b32 v167, s25
    v_mov_b32 v168, s25
    v_mov_b32 v169, s25
    v_mov_b32 v170, s25
    v_mov_b32 v171, s25
    v_mov_b32 v172, s25
    v_mov_b32 v173, s25
    v_mov_b32 v174, s25
    v_mov_b32 v175, s25
    s_sub_u32 s68, s68, 4210688
    s_sub_u32 s69, s69, 4210688
    s_mov_b32 s33, 1
    s_mov_b32 s35, 2
    s_waitcnt lgkmcnt(0)
    s_branch K1_LOOPX
K1_XDEF:
    s_waitcnt vmcnt(0)
    s_mov_b32 s96, 300000
POLL_20:
    v_cmp_gt_u32 vcc, 1, v28
    s_sub_u32 s96, s96, 1
    s_cbranch_vccz POLLD_21
    s_sleep 8
    buffer_load_dword v28, v29, s[84:87], 0 offen sc1
    s_waitcnt vmcnt(0)
    s_cmp_lg_u32 s96, 0
    s_cbranch_scc1 POLL_20
POLLD_21:
    v_mov_b32 v28, 1
    s_mov_b32 s33, 2
    s_mov_b32 s35, 14
    s_cmp_eq_u32 s32, 0
    s_cbranch_scc1 K1_XDE2
    s_mov_b32 s25, 18251776
    s_mov_b64 exec, 65535
    buffer_atomic_add v28, v248, s[16:19], s25 offen sc1
K1_XDE2:
    s_mov_b64 exec, 3
    buffer_atomic_add v28, v248, s[16:19], s74 offen offset:4 sc1
    s_mov_b64 exec, -1
    s_branch K1_LOOPX
K1_EPA:
    v_mov_b32 v4, 0x3fb8aa3b
    v_mov_b32 v5, 0x3fb8aa3b
    v_mov_b32 v6, 0xb5c1a2a0
    v_mov_b32 v7, 0xb5c1a2a0
    v_mov_b32 v8, 0x358637bd
    s_nop 3
    v_pk_fma_f32 v[176:177], v[112:113], v[4:5], v[6:7]
    v_pk_fma_f32 v[178:179], v[114:115], v[4:5], v[6:7]
    v_pk_fma_f32 v[180:181], v[116:117], v[4:5], v[6:7]
    v_pk_fma_f32 v[182:183], v[118:119], v[4:5], v[6:7]
    v_pk_fma_f32 v[184:185], v[120:121], v[4:5], v[6:7]
    v_pk_fma_f32 v[186:187], v[122:123], v[4:5], v[6:7]
    v_pk_fma_f32 v[188:189], v[124:125], v[4:5], v[6:7]
    v_pk_fma_f32 v[190:191], v[126:127], v[4:5], v[6:7]
    v_exp_f32 v176, v176 clamp
    v_max_f32 v112, v112, v8
    v_exp_f32 v177, v177 clamp
    v_max_f32 v113, v113, v8
    v_exp_f32 v178, v178 clamp
    v_max_f32 v114, v114, v8
    v_exp_f32 v179, v179 clamp
    v_max_f32 v115, v115, v8
    v_exp_f32 v180, v180 clamp
    v_max_f32 v116, v116, v8
    v_exp_f32 v181, v181 clamp
    v_max_f32 v117, v117, v8
    v_exp_f32 v182, v182 clamp
    v_max_f32 v118, v118, v8
    v_exp_f32 v183, v183 clamp
    v_max_f32 v119, v119, v8
    v_exp_f32 v184, v184 clamp
    v_max_f32 v120, v120, v8
    v_exp_f32 v185, v185 clamp
    v_max_f32 v121, v121, v8
    v_exp_f32 v186, v186 clamp
    v_max_f32 v122, v122, v8
    v_exp_f32 v187, v187 clamp
    v_max_f32 v123, v123, v8
    v_exp_f32 v188, v188 clamp
    v_max_f32 v124, v124, v8
    v_exp_f32 v189, v189 clamp
    v_max_f32 v125, v125, v8
    v_exp_f32 v190, v190 clamp
    v_max_f32 v126, v126, v8
    v_exp_f32 v191, v191 clamp
    v_max_f32 v127, v127, v8
    v_pk_add_f32 v[112:113], v[112:113], v[176:177]
    v_pk_add_f32 v[114:115], v[114:115], v[178:179]
    v_pk_add_f32 v[116:117], v[116:117], v[180:181]
    v_pk_add_f32 v[118:119], v[118:119], v[182:183]
    v_pk_add_f32 v[120:121], v[120:121], v[184:185]
    v_pk_add_f32 v[122:123], v[122:123], v[186:187]
    v_pk_add_f32 v[124:125], v[124:125], v[188:189]
    v_pk_add_f32 v[126:127], v[126:127], v[190:191]
    v_cvt_pk_bf16_f32 v112, v112, v113
    v_cvt_pk_bf16_f32 v113, v114, v115
    v_cvt_pk_bf16_f32 v114, v116, v117
    v_cvt_pk_bf16_f32 v115, v118, v119
    v_cvt_pk_bf16_f32 v116, v120, v121
    v_cvt_pk_bf16_f32 v117, v122, v123
    v_cvt_pk_bf16_f32 v118, v124, v125
    v_cvt_pk_bf16_f32 v119, v126, v127
    buffer_store_dwordx4 v[112:115], v31, s[16:19], s68 offen offset:0 sc1
    buffer_store_dwordx4 v[116:119], v31, s[16:19], s68 offen offset:256 sc1
    v_pk_fma_f32 v[176:177], v[128:129], v[4:5], v[6:7]
    v_pk_fma_f32 v[178:179], v[130:131], v[4:5], v[6:7]
    v_pk_fma_f32 v[180:181], v[132:133], v[4:5], v[6:7]
    v_pk_fma_f32 v[182:183], v[134:135], v[4:5], v[6:7]
    v_pk_fma_f32 v[184:185], v[136:137], v[4:5], v[6:7]
    v_pk_fma_f32 v[186:187], v[138:139], v[4:5], v[6:7]
    v_pk_fma_f32 v[188:189], v[140:141], v[4:5], v[6:7]
    v_pk_fma_f32 v[190:191], v[142:143], v[4:5], v[6:7]
    v_exp_f32 v176, v176 clamp
    v_max_f32 v128, v128, v8
    v_exp_f32 v177, v177 clamp
    v_max_f32 v129, v129, v8
    v_exp_f32 v178, v178 clamp
    v_max_f32 v130, v130, v8
    v_exp_f32 v179, v179 clamp
    v_max_f32 v131, v131, v8
    v_exp_f32 v180, v180 clamp
    v_max_f32 v132, v132, v8
    v_exp_f32 v181, v181 clamp
    v_max_f32 v133, v133, v8
    v_exp_f32 v182, v182 clamp
    v_max_f32 v134, v134, v8
    v_exp_f32 v183, v183 clamp
    v_max_f32 v135, v135, v8
    v_exp_f32 v184, v184 clamp
    v_max_f32 v136, v136, v8
    v_exp_f32 v185, v185 clamp
    v_max_f32 v137, v137, v8
    v_exp_f32 v186, v186 clamp
    v_max_f32 v138, v138, v8
    v_exp_f32 v187, v187 clamp
    v_max_f32 v139, v139, v8
    v_exp_f32 v188, v188 clamp
    v_max_f32 v140, v140, v8
    v_exp_f32 v189, v189 clamp
    v_max_f32 v141, v141, v8
    v_exp_f32 v190, v190 clamp
    v_max_f32 v142, v142, v8
    v_exp_f32 v191, v191 clamp
    v_max_f32 v143, v143, v8
    v_pk_add_f32 v[128:129], v[128:129], v[176:177]
    v_pk_add_f32 v[130:131], v[130:131], v[178:179]
    v_pk_add_f32 v[132:133], v[132:133], v[180:181]
    v_pk_add_f32 v[134:135], v[134:135], v[182:183]
    v_pk_add_f32 v[136:137], v[136:137], v[184:185]
    v_pk_add_f32 v[138:139], v[138:139], v[186:187]
    v_pk_add_f32 v[140:141], v[140:141], v[188:189]
    v_pk_add_f32 v[142:143], v[142:143], v[190:191]
    v_cvt_pk_bf16_f32 v128, v128, v129
    v_cvt_pk_bf16_f32 v129, v130, v131
    v_cvt_pk_bf16_f32 v130, v132, v133
    v_cvt_pk_bf16_f32 v131, v134, v135
    v_cvt_pk_bf16_f32 v132, v136, v137
    v_cvt_pk_bf16_f32 v133, v138, v139
    v_cvt_pk_bf16_f32 v134, v140, v141
    v_cvt_pk_bf16_f32 v135, v142, v143
    buffer_store_dwordx4 v[128:131], v31, s[16:19], s68 offen offset:2048 sc1
    buffer_store_dwordx4 v[132:135], v31, s[16:19], s68 offen offset:2304 sc1
    v_pk_fma_f32 v[176:177], v[144:145], v[4:5], v[6:7]
    v_pk_fma_f32 v[178:179], v[146:147], v[4:5], v[6:7]
    v_pk_fma_f32 v[180:181], v[148:149], v[4:5], v[6:7]
    v_pk_fma_f32 v[182:183], v[150:151], v[4:5], v[6:7]
    v_pk_fma_f32 v[184:185], v[152:153], v[4:5], v[6:7]
    v_pk_fma_f32 v[186:187], v[154:155], v[4:5], v[6:7]
    v_pk_fma_f32 v[188:189], v[156:157], v[4:5], v[6:7]
    v_pk_fma_f32 v[190:191], v[158:159], v[4:5], v[6:7]
    v_exp_f32 v176, v176 clamp
    v_max_f32 v144, v144, v8
    v_exp_f32 v177, v177 clamp
    v_max_f32 v145, v145, v8
    v_exp_f32 v178, v178 clamp
    v_max_f32 v146, v146, v8
    v_exp_f32 v179, v179 clamp
    v_max_f32 v147, v147, v8
    v_exp_f32 v180, v180 clamp
    v_max_f32 v148, v148, v8
    v_exp_f32 v181, v181 clamp
    v_max_f32 v149, v149, v8
    v_exp_f32 v182, v182 clamp
    v_max_f32 v150, v150, v8
    v_exp_f32 v183, v183 clamp
    v_max_f32 v151, v151, v8
    v_exp_f32 v184, v184 clamp
    v_max_f32 v152, v152, v8
    v_exp_f32 v185, v185 clamp
    v_max_f32 v153, v153, v8
    v_exp_f32 v186, v186 clamp
    v_max_f32 v154, v154, v8
    v_exp_f32 v187, v187 clamp
    v_max_f32 v155, v155, v8
    v_exp_f32 v188, v188 clamp
    v_max_f32 v156, v156, v8
    v_exp_f32 v189, v189 clamp
    v_max_f32 v157, v157, v8
    v_exp_f32 v190, v190 clamp
    v_max_f32 v158, v158, v8
    v_exp_f32 v191, v191 clamp
    v_max_f32 v159, v159, v8
    v_pk_add_f32 v[144:145], v[144:145], v[176:177]
    v_pk_add_f32 v[146:147], v[146:147], v[178:179]
    v_pk_add_f32 v[148:149], v[148:149], v[180:181]
    v_pk_add_f32 v[150:151], v[150:151], v[182:183]
    v_pk_add_f32 v[152:153], v[152:153], v[184:185]
    v_pk_add_f32 v[154:155], v[154:155], v[186:187]
    v_pk_add_f32 v[156:157], v[156:157], v[188:189]
    v_pk_add_f32 v[158:159], v[158:159], v[190:191]
    v_cvt_pk_bf16_f32 v144, v144, v145
    v_cvt_pk_bf16_f32 v145, v146, v147
    v_cvt_pk_bf16_f32 v146, v148, v149
    v_cvt_pk_bf16_f32 v147, v150, v151
    v_cvt_pk_bf16_f32 v148, v152, v153
    v_cvt_pk_bf16_f32 v149, v154, v155
    v_cvt_pk_bf16_f32 v150, v156, v157
    v_cvt_pk_bf16_f32 v151, v158, v159
    buffer_store_dwordx4 v[144:147], v31, s[16:19], s69 offen offset:0 sc1
    buffer_store_dwordx4 v[148:151], v31, s[16:19], s69 offen offset:256 sc1
    v_pk_fma_f32 v[176:177], v[160:161], v[4:5], v[6:7]
    v_pk_fma_f32 v[178:179], v[162:163], v[4:5], v[6:7]
    v_pk_fma_f32 v[180:181], v[164:165], v[4:5], v[6:7]
    v_pk_fma_f32 v[182:183], v[166:167], v[4:5], v[6:7]
    v_pk_fma_f32 v[184:185], v[168:169], v[4:5], v[6:7]
    v_pk_fma_f32 v[186:187], v[170:171], v[4:5], v[6:7]
    v_pk_fma_f32 v[188:189], v[172:173], v[4:5], v[6:7]
    v_pk_fma_f32 v[190:191], v[174:175], v[4:5], v[6:7]
    v_exp_f32 v176, v176 clamp
    v_max_f32 v160, v160, v8
    v_exp_f32 v177, v177 clamp
    v_max_f32 v161, v161, v8
    v_exp_f32 v178, v178 clamp
    v_max_f32 v162, v162, v8
    v_exp_f32 v179, v179 clamp
    v_max_f32 v163, v163, v8
    v_exp_f32 v180, v180 clamp
    v_max_f32 v164, v164, v8
    v_exp_f32 v181, v181 clamp
    v_max_f32 v165, v165, v8
    v_exp_f32 v182, v182 clamp
    v_max_f32 v166, v166, v8
    v_exp_f32 v183, v183 clamp
    v_max_f32 v167, v167, v8
    v_exp_f32 v184, v184 clamp
    v_max_f32 v168, v168, v8
    v_exp_f32 v185, v185 clamp
    v_max_f32 v169, v169, v8
    v_exp_f32 v186, v186 clamp
    v_max_f32 v170, v170, v8
    v_exp_f32 v187, v187 clamp
    v_max_f32 v171, v171, v8
    v_exp_f32 v188, v188 clamp
    v_max_f32 v172, v172, v8
    v_exp_f32 v189, v189 clamp
    v_max_f32 v173, v173, v8
    v_exp_f32 v190, v190 clamp
    v_max_f32 v174, v174, v8
    v_exp_f32 v191, v191 clamp
    v_max_f32 v175, v175, v8
    v_pk_add_f32 v[160:161], v[160:161], v[176:177]
    v_pk_add_f32 v[162:163], v[162:163], v[178:179]
    v_pk_add_f32 v[164:165], v[164:165], v[180:181]
    v_pk_add_f32 v[166:167], v[166:167], v[182:183]
    v_pk_add_f32 v[168:169], v[168:169], v[184:185]
    v_pk_add_f32 v[170:171], v[170:171], v[186:187]
    v_pk_add_f32 v[172:173], v[172:173], v[188:189]
    v_pk_add_f32 v[174:175], v[174:175], v[190:191]
    v_cvt_pk_bf16_f32 v160, v160, v161
    v_cvt_pk_bf16_f32 v161, v162, v163
    v_cvt_pk_bf16_f32 v162, v164, v165
    v_cvt_pk_bf16_f32 v163, v166, v167
    v_cvt_pk_bf16_f32 v164, v168, v169
    v_cvt_pk_bf16_f32 v165, v170, v171
    v_cvt_pk_bf16_f32 v166, v172, v173
    v_cvt_pk_bf16_f32 v167, v174, v175
    buffer_store_dwordx4 v[160:163], v31, s[16:19], s69 offen offset:2048 sc1
    buffer_store_dwordx4 v[164:167], v31, s[16:19], s69 offen offset:2304 sc1
    v_mov_b32 v172, v248
    s_branch K1_DONE
K1_Y:
    s_mov_b32 s80, 53248
    s_mov_b32 s25, 0x358637bd
    v_mov_b32 v112, s25
    v_mov_b32 v128, 0
    v_mov_b32 v113, s25
    v_mov_b32 v129, 0
    v_mov_b32 v114, s25
    v_mov_b32 v130, 0
    v_mov_b32 v115, s25
    v_mov_b32 v131, 0
    v_mov_b32 v116, s25
    v_mov_b32 v132, 0
    v_mov_b32 v117, s25
    v_mov_b32 v133, 0
    v_mov_b32 v118, s25
    v_mov_b32 v134, 0
    v_mov_b32 v119, s25
    v_mov_b32 v135, 0
    v_mov_b32 v120, s25
    v_mov_b32 v136, 0
    v_mov_b32 v121, s25
    v_mov_b32 v137, 0
    v_mov_b32 v122, s25
    v_mov_b32 v138, 0
    v_mov_b32 v123, s25
    v_mov_b32 v139, 0
    v_mov_b32 v124, s25
    v_mov_b32 v140, 0
    v_mov_b32 v125, s25
    v_mov_b32 v141, 0
    v_mov_b32 v126, s25
    v_mov_b32 v142, 0
    v_mov_b32 v127, s25
    v_mov_b32 v143, 0
    v_mov_b32 v144, s25
    v_mov_b32 v160, 0
    v_mov_b32 v145, s25
    v_mov_b32 v161, 0
    v_mov_b32 v146, s25
    v_mov_b32 v162, 0
    v_mov_b32 v147, s25
    v_mov_b32 v163, 0
    v_mov_b32 v148, s25
    v_mov_b32 v164, 0
    v_mov_b32 v149, s25
    v_mov_b32 v165, 0
    v_mov_b32 v150, s25
    v_mov_b32 v166, 0
    v_mov_b32 v151, s25
    v_mov_b32 v167, 0
    v_mov_b32 v152, s25
    v_mov_b32 v168, 0
    v_mov_b32 v153, s25
    v_mov_b32 v169, 0
    v_mov_b32 v154, s25
    v_mov_b32 v170, 0
    v_mov_b32 v155, s25
    v_mov_b32 v171, 0
    v_mov_b32 v156, s25
    v_mov_b32 v172, 0
    v_mov_b32 v157, s25
    v_mov_b32 v173, 0
    v_mov_b32 v158, s25
    v_mov_b32 v174, 0
    v_mov_b32 v159, s25
    v_mov_b32 v175, 0
    v_mov_b32 v176, s25
    v_mov_b32 v192, 0
    v_mov_b32 v177, s25
    v_mov_b32 v193, 0
    v_mov_b32 v178, s25
    v_mov_b32 v194, 0
    v_mov_b32 v179, s25
    v_mov_b32 v195, 0
    v_mov_b32 v180, s25
    v_mov_b32 v196, 0
    v_mov_b32 v181, s25
    v_mov_b32 v197, 0
    v_mov_b32 v182, s25
    v_mov_b32 v198, 0
    v_mov_b32 v183, s25
    v_mov_b32 v199, 0
    v_mov_b32 v184, s25
    v_mov_b32 v200, 0
    v_mov_b32 v185, s25
    v_mov_b32 v201, 0
    v_mov_b32 v186, s25
    v_mov_b32 v202, 0
    v_mov_b32 v187, s25
    v_mov_b32 v203, 0
    v_mov_b32 v188, s25
    v_mov_b32 v204, 0
    v_mov_b32 v189, s25
    v_mov_b32 v205, 0
    v_mov_b32 v190, s25
    v_mov_b32 v206, 0
    v_mov_b32 v191, s25
    v_mov_b32 v207, 0
    v_mov_b32 v208, s25
    v_mov_b32 v224, 0
    v_mov_b32 v209, s25
    v_mov_b32 v225, 0
    v_mov_b32 v210, s25
    v_mov_b32 v226, 0
    v_mov_b32 v211, s25
    v_mov_b32 v227, 0
    v_mov_b32 v212, s25
    v_mov_b32 v228, 0
    v_mov_b32 v213, s25
    v_mov_b32 v229, 0
    v_mov_b32 v214, s25
    v_mov_b32 v230, 0
    v_mov_b32 v215, s25
    v_mov_b32 v231, 0
    v_mov_b32 v216, s25
    v_mov_b32 v232, 0
    v_mov_b32 v217, s25
    v_mov_b32 v233, 0
    v_mov_b32 v218, s25
    v_mov_b32 v234, 0
    v_mov_b32 v219, s25
    v_mov_b32 v235, 0
    v_mov_b32 v220, s25
    v_mov_b32 v236, 0
    v_mov_b32 v221, s25
    v_mov_b32 v237, 0
    v_mov_b32 v222, s25
    v_mov_b32 v238, 0
    v_mov_b32 v223, s25
    v_mov_b32 v239, 0
    s_waitcnt lgkmcnt(0)
K1_MLY:
    s_barrier
    ds_read_b64_tr_b16 v[64:65], v18 offset:32768
    ds_read_b64_tr_b16 v[66:67], v18 offset:33792
    ds_read_b64_tr_b16 v[68:69], v19 offset:32768
    ds_read_b64_tr_b16 v[70:71], v19 offset:33792
    ds_read_b64_tr_b16 v[72:73], v20 offset:32768
    ds_read_b64_tr_b16 v[74:75], v20 offset:33792
    ds_read_b64_tr_b16 v[76:77], v21 offset:32768
    ds_read_b64_tr_b16 v[78:79], v21 offset:33792
    ds_read_b128 v[32:35], v16 offset:0
    ds_read_b128 v[36:39], v16 offset:2048
    ds_read_b128 v[40:43], v16 offset:4096
    ds_read_b128 v[44:47], v16 offset:6144
    ds_read_b128 v[48:51], v16 offset:8192
    ds_read_b128 v[52:55], v16 offset:10240
    ds_read_b128 v[56:59], v16 offset:12288
    ds_read_b128 v[60:63], v16 offset:14336
    s_waitcnt lgkmcnt(0)
K1_LOOPY:
    v_mfma_f32_16x16x32_bf16 v[112:115], v[32:35], v[64:67], v[112:115]
    s_waitcnt lgkmcnt(9)
    ds_read_b64_tr_b16 v[80:81], v18 offset:40960
    v_mfma_f32_16x16x32_bf16 v[120:123], v[32:35], v[68:71], v[120:123]
    s_waitcnt lgkmcnt(7)
    ds_read_b64_tr_b16 v[82:83], v18 offset:41984
    v_mfma_f32_16x16x32_bf16 v[128:131], v[32:35], v[72:75], v[128:131]
    s_waitcnt lgkmcnt(5)
    ds_read_b64_tr_b16 v[84:85], v19 offset:40960
    v_mfma_f32_16x16x32_bf16 v[136:139], v[32:35], v[76:79], v[136:139]
    ds_read_b128 v[32:35], v17 offset:0
    v_mfma_f32_16x16x32_bf16 v[116:119], v[36:39], v[64:67], v[116:119]
    ds_read_b64_tr_b16 v[86:87], v19 offset:41984
    v_mfma_f32_16x16x32_bf16 v[124:127], v[36:39], v[68:71], v[124:127]
    ds_read_b64_tr_b16 v[88:89], v20 offset:40960
    v_mfma_f32_16x16x32_bf16 v[132:135], v[36:39], v[72:75], v[132:135]
    ds_read_b64_tr_b16 v[90:91], v20 offset:41984
    v_mfma_f32_16x16x32_bf16 v[140:143], v[36:39], v[76:79], v[140:143]
    ds_read_b128 v[36:39], v17 offset:2048
    v_mfma_f32_16x16x32_bf16 v[144:147], v[40:43], v[64:67], v[144:147]
    ds_read_b64_tr_b16 v[92:93], v21 offset:40960
    v_mfma_f32_16x16x32_bf16 v[152:155], v[40:43], v[68:71], v[152:155]
    ds_read_b64_tr_b16 v[94:95], v21 offset:41984
    v_mfma_f32_16x16x32_bf16 v[160:163], v[40:43], v[72:75], v[160:163]
    s_add_u32 s34, s34, 1
    v_mfma_f32_16x16x32_bf16 v[168:171], v[40:43], v[76:79], v[168:171]
    ds_read_b128 v[40:43], v17 offset:4096
    v_mfma_f32_16x16x32_bf16 v[148:151], v[44:47], v[64:67], v[148:151]
    s_cmp_eq_u32 s34, 3
    v_mfma_f32_16x16x32_bf16 v[156:159], v[44:47], v[68:71], v[156:159]
    s_cselect_b32 s36, 4294860800, s80
    v_mfma_f32_16x16x32_bf16 v[164:167], v[44:47], v[72:75], v[164:167]
    s_cselect_b32 s34, 0, s34
    v_mfma_f32_16x16x32_bf16 v[172:175], v[44:47], v[76:79], v[172:175]
    ds_read_b128 v[44:47], v17 offset:6144
    v_mfma_f32_16x16x32_bf16 v[176:179], v[48:51], v[64:67], v[176:179]
    v_add_u32 v16, s36, v16
    v_mfma_f32_16x16x32_bf16 v[184:187], v[48:51], v[68:71], v[184:187]
    v_add_u32 v18, s36, v18
    v_mfma_f32_16x16x32_bf16 v[192:195], v[48:51], v[72:75], v[192:195]
    v_add_u32 v19, s36, v19
    v_mfma_f32_16x16x32_bf16 v[200:203], v[48:51], v[76:79], v[200:203]
    s_waitcnt lgkmcnt(14)
    ds_read_b128 v[48:51], v17 offset:8192
    v_mfma_f32_16x16x32_bf16 v[180:183], v[52:55], v[64:67], v[180:183]
    v_add_u32 v20, s36, v20
    v_mfma_f32_16x16x32_bf16 v[188:191], v[52:55], v[68:71], v[188:191]
    v_add_u32 v21, s36, v21
    v_mfma_f32_16x16x32_bf16 v[196:199], v[52:55], v[72:75], v[196:199]
    v_mfma_f32_16x16x32_bf16 v[204:207], v[52:55], v[76:79], v[204:207]
    s_waitcnt lgkmcnt(14)
    ds_read_b128 v[52:55], v17 offset:10240
    v_mfma_f32_16x16x32_bf16 v[208:211], v[56:59], v[64:67], v[208:211]
    v_mfma_f32_16x16x32_bf16 v[216:219], v[56:59], v[68:71], v[216:219]
    v_mfma_f32_16x16x32_bf16 v[224:227], v[56:59], v[72:75], v[224:227]
    v_mfma_f32_16x16x32_bf16 v[232:235], v[56:59], v[76:79], v[232:235]
    s_waitcnt lgkmcnt(14)
    ds_read_b128 v[56:59], v17 offset:12288
    v_mfma_f32_16x16x32_bf16 v[212:215], v[60:63], v[64:67], v[212:215]
    v_mfma_f32_16x16x32_bf16 v[220:223], v[60:63], v[68:71], v[220:223]
    v_mfma_f32_16x16x32_bf16 v[228:231], v[60:63], v[72:75], v[228:231]
    v_mfma_f32_16x16x32_bf16 v[236:239], v[60:63], v[76:79], v[236:239]
    s_waitcnt lgkmcnt(11)
    ds_read_b128 v[60:63], v17 offset:14336
    v_mfma_f32_16x16x32_bf16 v[112:115], v[32:35], v[80:83], v[112:115]
    s_waitcnt lgkmcnt(11)
    v_add_u32 v17, s36, v17
    v_mfma_f32_16x16x32_bf16 v[120:123], v[32:35], v[84:87], v[120:123]
    s_waitcnt lgkmcnt(9)
    v_mfma_f32_16x16x32_bf16 v[128:131], v[32:35], v[88:91], v[128:131]
    s_waitcnt lgkmcnt(6)
    v_mfma_f32_16x16x32_bf16 v[136:139], v[32:35], v[92:95], v[136:139]
    v_mfma_f32_16x16x32_bf16 v[116:119], v[36:39], v[80:83], v[116:119]
    v_mfma_f32_16x16x32_bf16 v[124:127], v[36:39], v[84:87], v[124:127]
    v_mfma_f32_16x16x32_bf16 v[132:135], v[36:39], v[88:91], v[132:135]
    v_mfma_f32_16x16x32_bf16 v[140:143], v[36:39], v[92:95], v[140:143]
    s_waitcnt lgkmcnt(0)
    s_barrier
    v_mfma_f32_16x16x32_bf16 v[144:147], v[40:43], v[80:83], v[144:147]
    ds_read_b128 v[32:35], v16 offset:0
    v_mfma_f32_16x16x32_bf16 v[152:155], v[40:43], v[84:87], v[152:155]
    ds_read_b128 v[36:39], v16 offset:2048
    v_mfma_f32_16x16x32_bf16 v[160:163], v[40:43], v[88:91], v[160:163]
    ds_read_b64_tr_b16 v[64:65], v18 offset:32768
    v_mfma_f32_16x16x32_bf16 v[168:171], v[40:43], v[92:95], v[168:171]
    ds_read_b128 v[40:43], v16 offset:4096
    v_mfma_f32_16x16x32_bf16 v[148:151], v[44:47], v[80:83], v[148:151]
    ds_read_b64_tr_b16 v[66:67], v18 offset:33792
    v_mfma_f32_16x16x32_bf16 v[156:159], v[44:47], v[84:87], v[156:159]
    ds_read_b64_tr_b16 v[68:69], v19 offset:32768
    v_mfma_f32_16x16x32_bf16 v[164:167], v[44:47], v[88:91], v[164:167]
    ds_read_b64_tr_b16 v[70:71], v19 offset:33792
    v_mfma_f32_16x16x32_bf16 v[172:175], v[44:47], v[92:95], v[172:175]
    ds_read_b128 v[44:47], v16 offset:6144
    v_mfma_f32_16x16x32_bf16 v[176:179], v[48:51], v[80:83], v[176:179]
    ds_read_b64_tr_b16 v[72:73], v20 offset:32768
    v_mfma_f32_16x16x32_bf16 v[184:187], v[48:51], v[84:87], v[184:187]
    ds_read_b64_tr_b16 v[74:75], v20 offset:33792
    v_mfma_f32_16x16x32_bf16 v[192:195], v[48:51], v[88:91], v[192:195]
    ds_read_b64_tr_b16 v[76:77], v21 offset:32768
    v_mfma_f32_16x16x32_bf16 v[200:203], v[48:51], v[92:95], v[200:203]
    ds_read_b128 v[48:51], v16 offset:8192
    v_mfma_f32_16x16x32_bf16 v[180:183], v[52:55], v[80:83], v[180:183]
    ds_read_b64_tr_b16 v[78:79], v21 offset:33792
    v_mfma_f32_16x16x32_bf16 v[188:191], v[52:55], v[84:87], v[188:191]
    s_sub_u32 s35, s35, 1
    v_mfma_f32_16x16x32_bf16 v[196:199], v[52:55], v[88:91], v[196:199]
    s_cmp_lg_u32 s35, 0
    v_mfma_f32_16x16x32_bf16 v[204:207], v[52:55], v[92:95], v[204:207]
    ds_read_b128 v[52:55], v16 offset:10240
    v_mfma_f32_16x16x32_bf16 v[208:211], v[56:59], v[80:83], v[208:211]
    v_mfma_f32_16x16x32_bf16 v[216:219], v[56:59], v[84:87], v[216:219]
    v_mfma_f32_16x16x32_bf16 v[224:227], v[56:59], v[88:91], v[224:227]
    v_mfma_f32_16x16x32_bf16 v[232:235], v[56:59], v[92:95], v[232:235]
    ds_read_b128 v[56:59], v16 offset:12288
    v_mfma_f32_16x16x32_bf16 v[212:215], v[60:63], v[80:83], v[212:215]
    v_mfma_f32_16x16x32_bf16 v[220:223], v[60:63], v[84:87], v[220:223]
    v_mfma_f32_16x16x32_bf16 v[228:231], v[60:63], v[88:91], v[228:231]
    v_mfma_f32_16x16x32_bf16 v[236:239], v[60:63], v[92:95], v[236:239]
    s_waitcnt lgkmcnt(10)
    ds_read_b128 v[60:63], v16 offset:14336
    s_cbranch_scc1 K1_LOOPY
    v_mov_b32 v4, 0x3fb8aa3b
    v_mov_b32 v5, 0x3fb8aa3b
    v_mov_b32 v6, 0xb5c1a2a0
    v_mov_b32 v7, 0xb5c1a2a0
    v_mov_b32 v8, 0x358637bd
    v_mov_b32 v12, 0x3f803f80
    v_mov_b32 v13, 0x3f803f80
    v_mov_b32 v14, 0x3f803f80
    v_mov_b32 v15, 0x3f803f80
    s_waitcnt vmcnt(0) lgkmcnt(0)
    v_pk_fma_f32 v[96:97], v[112:113], v[4:5], v[6:7]
    v_pk_fma_f32 v[98:99], v[114:115], v[4:5], v[6:7]
    v_pk_fma_f32 v[100:101], v[116:117], v[4:5], v[6:7]
    v_pk_fma_f32 v[102:103], v[118:119], v[4:5], v[6:7]
    v_pk_fma_f32 v[104:105], v[120:121], v[4:5], v[6:7]
    v_pk_fma_f32 v[106:107], v[122:123], v[4:5], v[6:7]
    v_pk_fma_f32 v[108:109], v[124:125], v[4:5], v[6:7]
    v_pk_fma_f32 v[110:111], v[126:127], v[4:5], v[6:7]
    v_exp_f32 v96, v96 clamp
    v_max_f32 v112, v112, v8
    v_exp_f32 v97, v97 clamp
    v_max_f32 v113, v113, v8
    v_exp_f32 v98, v98 clamp
    v_max_f32 v114, v114, v8
    v_exp_f32 v99, v99 clamp
    v_max_f32 v115, v115, v8
    v_exp_f32 v100, v100 clamp
    v_max_f32 v116, v116, v8
    v_exp_f32 v101, v101 clamp
    v_max_f32 v117, v117, v8
    v_exp_f32 v102, v102 clamp
    v_max_f32 v118, v118, v8
    v_exp_f32 v103, v103 clamp
    v_max_f32 v119, v119, v8
    v_exp_f32 v104, v104 clamp
    v_max_f32 v120, v120, v8
    v_exp_f32 v105, v105 clamp
    v_max_f32 v121, v121, v8
    v_exp_f32 v106, v106 clamp
    v_max_f32 v122, v122, v8
    v_exp_f32 v107, v107 clamp
    v_max_f32 v123, v123, v8
    v_exp_f32 v108, v108 clamp
    v_max_f32 v124, v124, v8
    v_exp_f32 v109, v109 clamp
    v_max_f32 v125, v125, v8
    v_exp_f32 v110, v110 clamp
    v_max_f32 v126, v126, v8
    v_exp_f32 v111, v111 clamp
    v_max_f32 v127, v127, v8
    v_pk_add_f32 v[112:113], v[112:113], v[96:97]
    v_pk_add_f32 v[114:115], v[114:115], v[98:99]
    v_pk_add_f32 v[116:117], v[116:117], v[100:101]
    v_pk_add_f32 v[118:119], v[118:119], v[102:103]
    v_pk_add_f32 v[120:121], v[120:121], v[104:105]
    v_pk_add_f32 v[122:123], v[122:123], v[106:107]
    v_pk_add_f32 v[124:125], v[124:125], v[108:109]
    v_pk_add_f32 v[126:127], v[126:127], v[110:111]
    v_cvt_pk_bf16_f32 v112, v112, v113
    v_cvt_pk_bf16_f32 v113, v114, v115
    v_cvt_pk_bf16_f32 v114, v116, v117
    v_cvt_pk_bf16_f32 v115, v118, v119
    v_cvt_pk_bf16_f32 v116, v120, v121
    v_cvt_pk_bf16_f32 v117, v122, v123
    v_cvt_pk_bf16_f32 v118, v124, v125
    v_cvt_pk_bf16_f32 v119, v126, v127
    v_cvt_pk_bf16_f32 v128, v128, v129
    v_cvt_pk_bf16_f32 v129, v130, v131
    v_cvt_pk_bf16_f32 v130, v132, v133
    v_cvt_pk_bf16_f32 v131, v134, v135
    v_cvt_pk_bf16_f32 v132, v136, v137
    v_cvt_pk_bf16_f32 v133, v138, v139
    v_cvt_pk_bf16_f32 v134, v140, v141
    v_cvt_pk_bf16_f32 v135, v142, v143
    v_pk_fma_f32 v[96:97], v[144:145], v[4:5], v[6:7]
    v_pk_fma_f32 v[98:99], v[146:147], v[4:5], v[6:7]
    v_pk_fma_f32 v[100:101], v[148:149], v[4:5], v[6:7]
    v_pk_fma_f32 v[102:103], v[150:151], v[4:5], v[6:7]
    v_pk_fma_f32 v[104:105], v[152:153], v[4:5], v[6:7]
    v_pk_fma_f32 v[106:107], v[154:155], v[4:5], v[6:7]
    v_pk_fma_f32 v[108:109], v[156:157], v[4:5], v[6:7]
    v_pk_fma_f32 v[110:111], v[158:159], v[4:5], v[6:7]
    v_exp_f32 v96, v96 clamp
    v_max_f32 v144, v144, v8
    v_mfma_f32_16x16x32_bf16 v[64:67], v[112:115], v[128:131], 0
    v_exp_f32 v97, v97 clamp
    v_max_f32 v145, v145, v8
    v_exp_f32 v98, v98 clamp
    v_max_f32 v146, v146, v8
    v_mfma_f32_16x16x32_bf16 v[68:71], v[112:115], v[132:135], 0
    v_exp_f32 v99, v99 clamp
    v_max_f32 v147, v147, v8
    v_exp_f32 v100, v100 clamp
    v_max_f32 v148, v148, v8
    v_mfma_f32_16x16x32_bf16 v[72:75], v[116:119], v[128:131], 0
    v_exp_f32 v101, v101 clamp
    v_max_f32 v149, v149, v8
    v_exp_f32 v102, v102 clamp
    v_max_f32 v150, v150, v8
    v_mfma_f32_16x16x32_bf16 v[76:79], v[116:119], v[132:135], 0
    v_exp_f32 v103, v103 clamp
    v_max_f32 v151, v151, v8
    v_exp_f32 v104, v104 clamp
    v_max_f32 v152, v152, v8
    v_mfma_f32_16x16x32_bf16 v[80:83], v[12:15], v[112:115], 0
    v_exp_f32 v105, v105 clamp
    v_max_f32 v153, v153, v8
    v_exp_f32 v106, v106 clamp
    v_max_f32 v154, v154, v8
    v_mfma_f32_16x16x32_bf16 v[84:87], v[12:15], v[116:119], 0
    v_exp_f32 v107, v107 clamp
    v_max_f32 v155, v155, v8
    v_exp_f32 v108, v108 clamp
    v_max_f32 v156, v156, v8
    v_exp_f32 v109, v109 clamp
    v_max_f32 v157, v157, v8
    v_exp_f32 v110, v110 clamp
    v_max_f32 v158, v158, v8
    v_exp_f32 v111, v111 clamp
    v_max_f32 v159, v159, v8
    v_pk_add_f32 v[144:145], v[144:145], v[96:97]
    v_pk_add_f32 v[146:147], v[146:147], v[98:99]
    v_pk_add_f32 v[148:149], v[148:149], v[100:101]
    v_pk_add_f32 v[150:151], v[150:151], v[102:103]
    v_pk_add_f32 v[152:153], v[152:153], v[104:105]
    v_pk_add_f32 v[154:155], v[154:155], v[106:107]
    v_pk_add_f32 v[156:157], v[156:157], v[108:109]
    v_pk_add_f32 v[158:159], v[158:159], v[110:111]
    v_cvt_pk_bf16_f32 v144, v144, v145
    v_cvt_pk_bf16_f32 v145, v146, v147
    v_cvt_pk_bf16_f32 v146, v148, v149
    v_cvt_pk_bf16_f32 v147, v150, v151
    v_cvt_pk_bf16_f32 v148, v152, v153
    v_cvt_pk_bf16_f32 v149, v154, v155
    v_cvt_pk_bf16_f32 v150, v156, v157
    v_cvt_pk_bf16_f32 v151, v158, v159
    v_cvt_pk_bf16_f32 v160, v160, v161
    v_cvt_pk_bf16_f32 v161, v162, v163
    v_cvt_pk_bf16_f32 v162, v164, v165
    v_cvt_pk_bf16_f32 v163, v166, v167
    v_cvt_pk_bf16_f32 v164, v168, v169
    v_cvt_pk_bf16_f32 v165, v170, v171
    v_cvt_pk_bf16_f32 v166, v172, v173
    v_cvt_pk_bf16_f32 v167, v174, v175
    v_pk_fma_f32 v[96:97], v[176:177], v[4:5], v[6:7]
    v_pk_fma_f32 v[98:99], v[178:179], v[4:5], v[6:7]
    v_pk_fma_f32 v[100:101], v[180:181], v[4:5], v[6:7]
    v_pk_fma_f32 v[102:103], v[182:183], v[4:5], v[6:7]
    v_pk_fma_f32 v[104:105], v[184:185], v[4:5], v[6:7]
    v_pk_fma_f32 v[106:107], v[186:187], v[4:5], v[6:7]
    v_pk_fma_f32 v[108:109], v[188:189], v[4:5], v[6:7]
    v_pk_fma_f32 v[110:111], v[190:191], v[4:5], v[6:7]
    v_exp_f32 v96, v96 clamp
    v_max_f32 v176, v176, v8
    v_mfma_f32_16x16x32_bf16 v[64:67], v[144:147], v[160:163], v[64:67]
    v_exp_f32 v97, v97 clamp
    v_max_f32 v177, v177, v8
    v_exp_f32 v98, v98 clamp
    v_max_f32 v178, v178, v8
    v_mfma_f32_16x16x32_bf16 v[68:71], v[144:147], v[164:167], v[68:71]
    v_exp_f32 v99, v99 clamp
    v_max_f32 v179, v179, v8
    v_exp_f32 v100, v100 clamp
    v_max_f32 v180, v180, v8
    v_mfma_f32_16x16x32_bf16 v[72:75], v[148:151], v[160:163], v[72:75]
    v_exp_f32 v101, v101 clamp
    v_max_f32 v181, v181, v8
    v_exp_f32 v102, v102 clamp
    v_max_f32 v182, v182, v8
    v_mfma_f32_16x16x32_bf16 v[76:79], v[148:151], v[164:167], v[76:79]
    v_exp_f32 v103, v103 clamp
    v_max_f32 v183, v183, v8
    v_exp_f32 v104, v104 clamp
    v_max_f32 v184, v184, v8
    v_mfma_f32_16x16x32_bf16 v[80:83], v[12:15], v[144:147], v[80:83]
    v_exp_f32 v105, v105 clamp
    v_max_f32 v185, v185, v8
    v_exp_f32 v106, v106 clamp
    v_max_f32 v186, v186, v8
    v_mfma_f32_16x16x32_bf16 v[84:87], v[12:15], v[148:151], v[84:87]
    v_exp_f32 v107, v107 clamp
    v_max_f32 v187, v187, v8
    v_exp_f32 v108, v108 clamp
    v_max_f32 v188, v188, v8
    v_exp_f32 v109, v109 clamp
    v_max_f32 v189, v189, v8
    v_exp_f32 v110, v110 clamp
    v_max_f32 v190, v190, v8
    v_exp_f32 v111, v111 clamp
    v_max_f32 v191, v191, v8
    v_pk_add_f32 v[176:177], v[176:177], v[96:97]
    v_pk_add_f32 v[178:179], v[178:179], v[98:99]
    v_pk_add_f32 v[180:181], v[180:181], v[100:101]
    v_pk_add_f32 v[182:183], v[182:183], v[102:103]
    v_pk_add_f32 v[184:185], v[184:185], v[104:105]
    v_pk_add_f32 v[186:187], v[186:187], v[106:107]
    v_pk_add_f32 v[188:189], v[188:189], v[108:109]
    v_pk_add_f32 v[190:191], v[190:191], v[110:111]
    v_cvt_pk_bf16_f32 v176, v176, v177
    v_cvt_pk_bf16_f32 v177, v178, v179
    v_cvt_pk_bf16_f32 v178, v180, v181
    v_cvt_pk_bf16_f32 v179, v182, v183
    v_cvt_pk_bf16_f32 v180, v184, v185
    v_cvt_pk_bf16_f32 v181, v186, v187
    v_cvt_pk_bf16_f32 v182, v188, v189
    v_cvt_pk_bf16_f32 v183, v190, v191
    v_cvt_pk_bf16_f32 v192, v192, v193
    v_cvt_pk_bf16_f32 v193, v194, v195
    v_cvt_pk_bf16_f32 v194, v196, v197
    v_cvt_pk_bf16_f32 v195, v198, v199
    v_cvt_pk_bf16_f32 v196, v200, v201
    v_cvt_pk_bf16_f32 v197, v202, v203
    v_cvt_pk_bf16_f32 v198, v204, v205
    v_cvt_pk_bf16_f32 v199, v206, v207
    v_pk_fma_f32 v[96:97], v[208:209], v[4:5], v[6:7]
    v_pk_fma_f32 v[98:99], v[210:211], v[4:5], v[6:7]
    v_pk_fma_f32 v[100:101], v[212:213], v[4:5], v[6:7]
    v_pk_fma_f32 v[102:103], v[214:215], v[4:5], v[6:7]
    v_pk_fma_f32 v[104:105], v[216:217], v[4:5], v[6:7]
    v_pk_fma_f32 v[106:107], v[218:219], v[4:5], v[6:7]
    v_pk_fma_f32 v[108:109], v[220:221], v[4:5], v[6:7]
    v_pk_fma_f32 v[110:111], v[222:223], v[4:5], v[6:7]
    v_exp_f32 v96, v96 clamp
    v_max_f32 v208, v208, v8
    v_mfma_f32_16x16x32_bf16 v[64:67], v[176:179], v[192:195], v[64:67]
    v_exp_f32 v97, v97 clamp
    v_max_f32 v209, v209, v8
    v_exp_f32 v98, v98 clamp
    v_max_f32 v210, v210, v8
    v_mfma_f32_16x16x32_bf16 v[68:71], v[176:179], v[196:199], v[68:71]
    v_exp_f32 v99, v99 clamp
    v_max_f32 v211, v211, v8
    v_exp_f32 v100, v100 clamp
    v_max_f32 v212, v212, v8
    v_mfma_f32_16x16x32_bf16 v[72:75], v[180:183], v[192:195], v[72:75]
    v_exp_f32 v101, v101 clamp
    v_max_f32 v213, v213, v8
    v_exp_f32 v102, v102 clamp
    v_max_f32 v214, v214, v8
    v_mfma_f32_16x16x32_bf16 v[76:79], v[180:183], v[196:199], v[76:79]
    v_exp_f32 v103, v103 clamp
    v_max_f32 v215, v215, v8
    v_exp_f32 v104, v104 clamp
    v_max_f32 v216, v216, v8
    v_mfma_f32_16x16x32_bf16 v[80:83], v[12:15], v[176:179], v[80:83]
    v_exp_f32 v105, v105 clamp
    v_max_f32 v217, v217, v8
    v_exp_f32 v106, v106 clamp
    v_max_f32 v218, v218, v8
    v_mfma_f32_16x16x32_bf16 v[84:87], v[12:15], v[180:183], v[84:87]
    v_exp_f32 v107, v107 clamp
    v_max_f32 v219, v219, v8
    v_exp_f32 v108, v108 clamp
    v_max_f32 v220, v220, v8
    v_exp_f32 v109, v109 clamp
    v_max_f32 v221, v221, v8
    v_exp_f32 v110, v110 clamp
    v_max_f32 v222, v222, v8
    v_exp_f32 v111, v111 clamp
    v_max_f32 v223, v223, v8
    v_pk_add_f32 v[208:209], v[208:209], v[96:97]
    v_pk_add_f32 v[210:211], v[210:211], v[98:99]
    v_pk_add_f32 v[212:213], v[212:213], v[100:101]
    v_pk_add_f32 v[214:215], v[214:215], v[102:103]
    v_pk_add_f32 v[216:217], v[216:217], v[104:105]
    v_pk_add_f32 v[218:219], v[218:219], v[106:107]
    v_pk_add_f32 v[220:221], v[220:221], v[108:109]
    v_pk_add_f32 v[222:223], v[222:223], v[110:111]
    v_cvt_pk_bf16_f32 v208, v208, v209
    v_cvt_pk_bf16_f32 v209, v210, v211
    v_cvt_pk_bf16_f32 v210, v212, v213
    v_cvt_pk_bf16_f32 v211, v214, v215
    v_cvt_pk_bf16_f32 v212, v216, v217
    v_cvt_pk_bf16_f32 v213, v218, v219
    v_cvt_pk_bf16_f32 v214, v220, v221
    v_cvt_pk_bf16_f32 v215, v222, v223
    v_cvt_pk_bf16_f32 v224, v224, v225
    v_cvt_pk_bf16_f32 v225, v226, v227
    v_cvt_pk_bf16_f32 v226, v228, v229
    v_cvt_pk_bf16_f32 v227, v230, v231
    v_cvt_pk_bf16_f32 v228, v232, v233
    v_cvt_pk_bf16_f32 v229, v234, v235
    v_cvt_pk_bf16_f32 v230, v236, v237
    v_cvt_pk_bf16_f32 v231, v238, v239
    s_lshl_b32 s25, s39, 13
    v_add_u32 v5, s25, v3
    v_mfma_f32_16x16x32_bf16 v[64:67], v[208:211], v[224:227], v[64:67]
    v_mfma_f32_16x16x32_bf16 v[68:71], v[208:211], v[228:231], v[68:71]
    v_mfma_f32_16x16x32_bf16 v[72:75], v[212:215], v[224:227], v[72:75]
    v_mfma_f32_16x16x32_bf16 v[76:79], v[212:215], v[228:231], v[76:79]
    v_mfma_f32_16x16x32_bf16 v[80:83], v[12:15], v[208:211], v[80:83]
    v_mfma_f32_16x16x32_bf16 v[84:87], v[12:15], v[212:215], v[84:87]
    s_lshl_b32 s25, s24, 1
    s_add_u32 s25, s25, s39
    s_lshl_b32 s74, s25, 7
    s_add_u32 s74, s74, 18186240
    s_lshl_b32 s68, s25, 3
    s_add_u32 s68, s68, s23
    s_lshl_b32 s69, s68, 7
    s_add_u32 s69, s69, 18153472
    s_lshl_b32 s68, s68, 12
    s_add_u32 s68, s68, 17104896
    v_and_b32 v4, 31, v2
    v_lshlrev_b32 v4, 2, v4
    v_lshlrev_b32 v172, 12, v2
    v_and_b32 v6, 16, v2
    v_cmp_eq_u32 vcc, 0, v6
    v_and_b32 v6, 32, v2
    v_lshl_add_u32 v6, v6, 5, v31
    v_cndmask_b32 v80, v84, v80, vcc
    s_lshl_b32 s25, s39, 2
    s_add_u32 s25, s25, 159760
    s_cmp_eq_u32 s38, 0
    s_cbranch_scc1 K1_KVR
    ds_write_b128 v5, v[64:67] offset:0
    ds_write_b128 v5, v[68:71] offset:1024
    ds_write_b128 v5, v[72:75] offset:2048
    ds_write_b128 v5, v[76:79] offset:3072
    ds_write_b32 v5, v80 offset:4096
    v_mov_b32 v8, s25
    v_mov_b32 v9, 1
    s_waitcnt lgkmcnt(0)
    ds_write_b32 v8, v9
    s_mov_b64 s[92:93], 0
    s_branch K1_DONE
K1_KVR:
    v_mov_b32 v8, s25
LFW_22:
    ds_read_b32 v9, v8
    s_waitcnt lgkmcnt(0)
    v_cmp_eq_u32 vcc, 0, v9
    s_nop 0
    s_cbranch_vccnz LFW_22
    ds_read_b128 v[32:35], v5 offset:0
    ds_read_b128 v[36:39], v5 offset:1024
    ds_read_b128 v[40:43], v5 offset:2048
    ds_read_b128 v[44:47], v5 offset:3072
    ds_read_b32 v48, v5 offset:4096
    s_mov_b64 s[92:93], 0xff
    s_waitcnt lgkmcnt(0)
    v_pk_add_f32 v[64:65], v[64:65], v[32:33]
    v_pk_add_f32 v[66:67], v[66:67], v[34:35]
    v_pk_add_f32 v[68:69], v[68:69], v[36:37]
    v_pk_add_f32 v[70:71], v[70:71], v[38:39]
    v_pk_add_f32 v[72:73], v[72:73], v[40:41]
    v_pk_add_f32 v[74:75], v[74:75], v[42:43]
    v_pk_add_f32 v[76:77], v[76:77], v[44:45]
    v_pk_add_f32 v[78:79], v[78:79], v[46:47]
    v_add_f32 v80, v80, v48
    buffer_store_dwordx4 v[64:67], v6, s[16:19], s68 offen offset:0 sc1
    buffer_store_dwordx4 v[68:71], v6, s[16:19], s68 offen offset:256 sc1
    buffer_store_dwordx4 v[72:75], v6, s[16:19], s68 offen offset:1024 sc1
    buffer_store_dwordx4 v[76:79], v6, s[16:19], s68 offen offset:1280 sc1
    buffer_store_dword v80, v4, s[16:19], s69 offen sc1
K1_DONE:
    s_waitcnt lgkmcnt(0)
    v_lshlrev_b32 v1, 4, v2
    s_lshl_b32 s25, s22, 12
    v_add_u32 v3, 81920, v1
    v_add_u32 v5, s25, v1
    s_barrier
    ds_read_b128 v[28:31], v3
    ds_read_b128 v[16:19], v5 offset:16384
    ds_read_b128 v[128:131], v5 offset:18432
    ds_read_b128 v[32:35], v3 offset:1024
    ds_read_b128 v[20:23], v5 offset:17408
    ds_read_b128 v[132:135], v5 offset:19456
    ds_read_b128 v[36:39], v3 offset:2048
    s_and_b32 s23, s2, 31
    s_lshr_b32 s24, s2, 5
    v_lshlrev_b32 v1, 4, v2
    v_lshrrev_b32 v7, 5, v2
    s_and_b32 s26, s22, 3
    s_lshl_b32 s29, s24, 2
    s_add_u32 s29, s29, s26
    s_mul_i32 s29, s29, 131584
    s_lshl_b32 s25, s23, 11
    s_add_u32 s29, s29, s25
    v_mov_b32 v8, 0x3f803f80
    v_bfe_u32 v9, v2, 2, 1
    v_cmp_eq_u32 vcc, 0, v9
    v_and_b32 v9, 1, v2
    v_mov_b32 v62, 0x44444444
    v_cndmask_b32 v24, 0, v8, vcc
    v_xor_b32 v26, v24, v8
    v_mul_u32_u24 v9, 0xaaaa, v9
    v_mov_b32 v25, v24
    v_mov_b32 v27, v26
    v_or_b32 v62, v62, v9
    v_add_u32 v4, 16384, v3
    v_pk_mov_b32 v[40:41], 0, 0
    v_pk_mov_b32 v[42:43], 0, 0
    v_pk_mov_b32 v[44:45], 0, 0
    v_pk_mov_b32 v[46:47], 0, 0
    v_pk_mov_b32 v[48:49], 0, 0
    v_pk_mov_b32 v[50:51], 0, 0
    v_pk_mov_b32 v[52:53], 0, 0
    v_pk_mov_b32 v[54:55], 0, 0
    v_pk_mov_b32 v[56:57], 0, 0
    v_pk_mov_b32 v[58:59], 0, 0
    v_pk_mov_b32 v[60:61], 0, 0
    s_mov_b32 s35, 0
    s_waitcnt lgkmcnt(4)
    v_mfma_f32_32x32x16_bf16 v[64:79], v[28:31], v[16:19], 0
    v_mfma_f32_32x32x16_bf16 v[80:95], v[28:31], v[128:131], 0
    s_waitcnt lgkmcnt(1)
    v_mfma_f32_32x32x16_bf16 v[64:79], v[32:35], v[20:23], v[64:79]
    v_mfma_f32_32x32x16_bf16 v[80:95], v[32:35], v[132:135], v[80:95]
    v_mov_b32 v96, 0
    v_mov_b32 v97, 0
    v_mov_b32 v98, 0
    v_mov_b32 v99, 0
    v_mov_b32 v100, 0
    v_mov_b32 v101, 0
    v_mov_b32 v102, 0
    v_mov_b32 v103, 0
    v_mov_b32 v104, 0
    v_mov_b32 v105, 0
    v_mov_b32 v106, 0
    v_mov_b32 v107, 0
    v_mov_b32 v108, 0
    v_mov_b32 v109, 0
    v_mov_b32 v110, 0
    v_mov_b32 v111, 0
    v_max3_f32 v8, v64, v65, v66
    v_max3_f32 v9, v67, v68, v69
    v_max3_f32 v8, v8, v70, v71
    v_max3_f32 v9, v9, v72, v73
    v_max3_f32 v8, v8, v74, v75
    v_max3_f32 v9, v9, v76, v77
    v_max3_f32 v8, v8, v78, v79
    v_max_f32 v8, v8, v9
    v_mov_b32 v9, v8
    v_mov_b32 v140, 0
    v_mov_b32 v141, 0
    v_mov_b32 v142, 0
    v_mov_b32 v143, 0
    v_mov_b32 v144, 0
    v_mov_b32 v145, 0
    v_mov_b32 v146, 0
    v_mov_b32 v147, 0
    v_mov_b32 v148, 0
    v_mov_b32 v149, 0
    v_mov_b32 v150, 0
    v_mov_b32 v151, 0
    v_mov_b32 v152, 0
    v_mov_b32 v153, 0
    v_mov_b32 v154, 0
    v_mov_b32 v155, 0
    v_max3_f32 v10, v80, v81, v82
    v_max3_f32 v11, v83, v84, v85
    v_max3_f32 v10, v10, v86, v87
    v_max3_f32 v11, v11, v88, v89
    v_max3_f32 v10, v10, v90, v91
    v_max3_f32 v11, v11, v92, v93
    v_max3_f32 v10, v10, v94, v95
    v_max_f32 v10, v10, v11
    v_mov_b32 v11, v10
    s_nop 0
    v_permlane32_swap_b32 v8, v9
    v_permlane32_swap_b32 v10, v11
    v_max_f32 v8, v8, v9
    v_max_f32 v10, v10, v11
    v_sub_f32 v156, 0, v10
    v_sub_f32 v157, 0, v10
    v_pk_mov_b32 v[158:159], v[156:157], v[156:157]
    v_pk_mov_b32 v[160:161], v[156:157], v[156:157]
    v_pk_mov_b32 v[162:163], v[156:157], v[156:157]
    v_pk_mov_b32 v[164:165], v[156:157], v[156:157]
    v_pk_mov_b32 v[166:167], v[156:157], v[156:157]
    v_pk_mov_b32 v[168:169], v[156:157], v[156:157]
    v_pk_mov_b32 v[170:171], v[156:157], v[156:157]
    v_sub_f32 v112, 0, v8
    v_sub_f32 v113, 0, v8
    v_pk_mov_b32 v[114:115], v[112:113], v[112:113]
    v_pk_mov_b32 v[116:117], v[112:113], v[112:113]
    v_pk_mov_b32 v[118:119], v[112:113], v[112:113]
    v_pk_mov_b32 v[120:121], v[112:113], v[112:113]
    v_pk_mov_b32 v[122:123], v[112:113], v[112:113]
    v_pk_mov_b32 v[124:125], v[112:113], v[112:113]
    v_pk_mov_b32 v[126:127], v[112:113], v[112:113]
    v_pk_add_f32 v[64:65], v[64:65], v[112:113]
    v_pk_add_f32 v[66:67], v[66:67], v[112:113]
    v_pk_add_f32 v[68:69], v[68:69], v[112:113]
    v_pk_add_f32 v[70:71], v[70:71], v[112:113]
    v_pk_add_f32 v[72:73], v[72:73], v[112:113]
    v_pk_add_f32 v[74:75], v[74:75], v[112:113]
    v_pk_add_f32 v[76:77], v[76:77], v[112:113]
    v_pk_add_f32 v[78:79], v[78:79], v[112:113]
    s_mov_b32 s33, 1
    v_add_u32 v4, 32768, v3
    s_waitcnt lgkmcnt(0)
    v_mfma_f32_32x32x16_bf16 v[80:95], v[28:31], v[128:131], v[156:171]
K2_LOOP:
    ds_read_b128 v[28:31], v3 offset:4096
    v_cvt_pk_bf16_f32 v51, v60, v61
    v_exp_f32 v64, v64
    v_exp_f32 v65, v65
    v_exp_f32 v66, v66
    v_smfmac_f32_16x16x64_bf16 v[56:59], v[24:27], v[44:51], v62
    v_exp_f32 v67, v67
    v_exp_f32 v68, v68
    v_mfma_f32_32x32x16_bf16 v[80:95], v[32:35], v[132:135], v[80:95]
    ds_read_b128 v[32:35], v3 offset:5120
    v_cvt_pk_bf16_f32 v44, v64, v65
    v_cvt_pk_bf16_f32 v45, v66, v67
    v_exp_f32 v69, v69
    v_exp_f32 v70, v70
    v_mfma_f32_32x32x16_bf16 v[140:155], v[40:43], v[48:51], v[140:155]
    s_waitcnt lgkmcnt(2)
    ds_read_b128 v[40:43], v3 offset:3072
    v_exp_f32 v71, v71
    v_cvt_pk_bf16_f32 v46, v68, v69
    v_exp_f32 v72, v72
    v_cvt_pk_bf16_f32 v47, v70, v71
    v_exp_f32 v73, v73
    v_exp_f32 v74, v74
    v_mfma_f32_32x32x16_bf16 v[96:111], v[36:39], v[44:47], v[96:111]
    s_waitcnt lgkmcnt(2)
    v_exp_f32 v75, v75
    v_cvt_pk_bf16_f32 v48, v72, v73
    v_exp_f32 v76, v76
    v_cvt_pk_bf16_f32 v49, v74, v75
    v_exp_f32 v77, v77
    v_exp_f32 v60, v78
    v_exp_f32 v61, v79
    v_cvt_pk_bf16_f32 v50, v76, v77
    v_mfma_f32_32x32x16_bf16 v[64:79], v[28:31], v[16:19], v[112:127]
    v_cvt_pk_bf16_f32 v51, v60, v61
    v_exp_f32 v80, v80
    v_exp_f32 v81, v81
    v_exp_f32 v82, v82
    v_smfmac_f32_16x16x64_bf16 v[52:55], v[24:27], v[44:51], v62
    s_waitcnt lgkmcnt(1)
    v_exp_f32 v83, v83
    v_exp_f32 v84, v84
    v_mfma_f32_32x32x16_bf16 v[64:79], v[32:35], v[20:23], v[64:79]
    s_waitcnt lgkmcnt(0)
    v_cvt_pk_bf16_f32 v44, v80, v81
    v_cvt_pk_bf16_f32 v45, v82, v83
    v_exp_f32 v85, v85
    v_exp_f32 v86, v86
    v_mfma_f32_32x32x16_bf16 v[96:111], v[40:43], v[48:51], v[96:111]
    v_exp_f32 v87, v87
    v_cvt_pk_bf16_f32 v46, v84, v85
    v_exp_f32 v88, v88
    v_cvt_pk_bf16_f32 v47, v86, v87
    v_exp_f32 v89, v89
    v_exp_f32 v90, v90
    v_mfma_f32_32x32x16_bf16 v[140:155], v[36:39], v[44:47], v[140:155]
    ds_read_b128 v[36:39], v3 offset:6144
    v_exp_f32 v91, v91
    v_cvt_pk_bf16_f32 v48, v88, v89
    v_exp_f32 v92, v92
    v_cvt_pk_bf16_f32 v49, v90, v91
    v_exp_f32 v93, v93
    v_exp_f32 v60, v94
    v_exp_f32 v61, v95
    v_cvt_pk_bf16_f32 v50, v92, v93
    v_mfma_f32_32x32x16_bf16 v[80:95], v[28:31], v[128:131], v[156:171]
    ds_read_b128 v[28:31], v3 offset:8192
    v_cvt_pk_bf16_f32 v51, v60, v61
    v_exp_f32 v64, v64
    v_exp_f32 v65, v65
    v_exp_f32 v66, v66
    v_smfmac_f32_16x16x64_bf16 v[56:59], v[24:27], v[44:51], v62
    v_exp_f32 v67, v67
    v_exp_f32 v68, v68
    v_mfma_f32_32x32x16_bf16 v[80:95], v[32:35], v[132:135], v[80:95]
    ds_read_b128 v[32:35], v3 offset:9216
    v_cvt_pk_bf16_f32 v44, v64, v65
    v_cvt_pk_bf16_f32 v45, v66, v67
    v_exp_f32 v69, v69
    v_exp_f32 v70, v70
    v_mfma_f32_32x32x16_bf16 v[140:155], v[40:43], v[48:51], v[140:155]
    s_waitcnt lgkmcnt(2)
    ds_read_b128 v[40:43], v3 offset:7168
    v_exp_f32 v71, v71
    v_cvt_pk_bf16_f32 v46, v68, v69
    v_exp_f32 v72, v72
    v_cvt_pk_bf16_f32 v47, v70, v71
    v_exp_f32 v73, v73
    v_exp_f32 v74, v74
    v_mfma_f32_32x32x16_bf16 v[96:111], v[36:39], v[44:47], v[96:111]
    s_waitcnt lgkmcnt(2)
    v_exp_f32 v75, v75
    v_cvt_pk_bf16_f32 v48, v72, v73
    v_exp_f32 v76, v76
    v_cvt_pk_bf16_f32 v49, v74, v75
    v_exp_f32 v77, v77
    v_exp_f32 v60, v78
    v_exp_f32 v61, v79
    v_cvt_pk_bf16_f32 v50, v76, v77
    v_mfma_f32_32x32x16_bf16 v[64:79], v[28:31], v[16:19], v[112:127]
    v_cvt_pk_bf16_f32 v51, v60, v61
    v_exp_f32 v80, v80
    v_exp_f32 v81, v81
    v_exp_f32 v82, v82
    v_smfmac_f32_16x16x64_bf16 v[52:55], v[24:27], v[44:51], v62
    s_waitcnt lgkmcnt(1)
    v_exp_f32 v83, v83
    v_exp_f32 v84, v84
    v_mfma_f32_32x32x16_bf16 v[64:79], v[32:35], v[20:23], v[64:79]
    s_waitcnt lgkmcnt(0)
    v_cvt_pk_bf16_f32 v44, v80, v81
    v_cvt_pk_bf16_f32 v45, v82, v83
    v_exp_f32 v85, v85
    v_exp_f32 v86, v86
    v_mfma_f32_32x32x16_bf16 v[96:111], v[40:43], v[48:51], v[96:111]
    v_exp_f32 v87, v87
    v_cvt_pk_bf16_f32 v46, v84, v85
    v_exp_f32 v88, v88
    v_cvt_pk_bf16_f32 v47, v86, v87
    v_exp_f32 v89, v89
    v_exp_f32 v90, v90
    v_mfma_f32_32x32x16_bf16 v[140:155], v[36:39], v[44:47], v[140:155]
    ds_read_b128 v[36:39], v3 offset:10240
    v_exp_f32 v91, v91
    v_cvt_pk_bf16_f32 v48, v88, v89
    v_exp_f32 v92, v92
    v_cvt_pk_bf16_f32 v49, v90, v91
    v_exp_f32 v93, v93
    v_exp_f32 v60, v94
    v_exp_f32 v61, v95
    v_cvt_pk_bf16_f32 v50, v92, v93
    v_mfma_f32_32x32x16_bf16 v[80:95], v[28:31], v[128:131], v[156:171]
    ds_read_b128 v[28:31], v3 offset:12288
    v_cvt_pk_bf16_f32 v51, v60, v61
    v_exp_f32 v64, v64
    v_exp_f32 v65, v65
    v_exp_f32 v66, v66
    v_smfmac_f32_16x16x64_bf16 v[56:59], v[24:27], v[44:51], v62
    v_exp_f32 v67, v67
    v_exp_f32 v68, v68
    v_mfma_f32_32x32x16_bf16 v[80:95], v[32:35], v[132:135], v[80:95]
    ds_read_b128 v[32:35], v3 offset:13312
    v_cvt_pk_bf16_f32 v44, v64, v65
    v_cvt_pk_bf16_f32 v45, v66, v67
    v_exp_f32 v69, v69
    v_exp_f32 v70, v70
    v_mfma_f32_32x32x16_bf16 v[140:155], v[40:43], v[48:51], v[140:155]
    s_waitcnt lgkmcnt(2)
    ds_read_b128 v[40:43], v3 offset:11264
    v_exp_f32 v71, v71
    v_cvt_pk_bf16_f32 v46, v68, v69
    v_exp_f32 v72, v72
    v_cvt_pk_bf16_f32 v47, v70, v71
    v_exp_f32 v73, v73
    v_exp_f32 v74, v74
    v_mfma_f32_32x32x16_bf16 v[96:111], v[36:39], v[44:47], v[96:111]
    s_waitcnt lgkmcnt(2)
    v_exp_f32 v75, v75
    v_cvt_pk_bf16_f32 v48, v72, v73
    v_exp_f32 v76, v76
    v_cvt_pk_bf16_f32 v49, v74, v75
    v_exp_f32 v77, v77
    v_exp_f32 v60, v78
    v_exp_f32 v61, v79
    v_cvt_pk_bf16_f32 v50, v76, v77
    v_mfma_f32_32x32x16_bf16 v[64:79], v[28:31], v[16:19], v[112:127]
    s_barrier
    v_cvt_pk_bf16_f32 v51, v60, v61
    v_exp_f32 v80, v80
    v_exp_f32 v81, v81
    v_exp_f32 v82, v82
    v_smfmac_f32_16x16x64_bf16 v[52:55], v[24:27], v[44:51], v62
    s_waitcnt lgkmcnt(1)
    v_exp_f32 v83, v83
    v_exp_f32 v84, v84
    v_mfma_f32_32x32x16_bf16 v[64:79], v[32:35], v[20:23], v[64:79]
    s_waitcnt lgkmcnt(0)
    v_cvt_pk_bf16_f32 v44, v80, v81
    v_cvt_pk_bf16_f32 v45, v82, v83
    v_exp_f32 v85, v85
    v_exp_f32 v86, v86
    v_mfma_f32_32x32x16_bf16 v[96:111], v[40:43], v[48:51], v[96:111]
    v_exp_f32 v87, v87
    v_cvt_pk_bf16_f32 v46, v84, v85
    v_exp_f32 v88, v88
    v_cvt_pk_bf16_f32 v47, v86, v87
    v_exp_f32 v89, v89
    v_exp_f32 v90, v90
    v_mfma_f32_32x32x16_bf16 v[140:155], v[36:39], v[44:47], v[140:155]
    ds_read_b128 v[36:39], v3 offset:14336
    v_exp_f32 v91, v91
    v_cvt_pk_bf16_f32 v48, v88, v89
    v_exp_f32 v92, v92
    v_cvt_pk_bf16_f32 v49, v90, v91
    v_exp_f32 v93, v93
    v_exp_f32 v60, v94
    v_exp_f32 v61, v95
    v_cvt_pk_bf16_f32 v50, v92, v93
    v_mfma_f32_32x32x16_bf16 v[80:95], v[28:31], v[128:131], v[156:171]
    ds_read_b128 v[28:31], v3 offset:16384
    v_cvt_pk_bf16_f32 v51, v60, v61
    v_exp_f32 v64, v64
    v_exp_f32 v65, v65
    v_exp_f32 v66, v66
    v_smfmac_f32_16x16x64_bf16 v[56:59], v[24:27], v[44:51], v62
    v_exp_f32 v67, v67
    v_exp_f32 v68, v68
    v_mfma_f32_32x32x16_bf16 v[80:95], v[32:35], v[132:135], v[80:95]
    ds_read_b128 v[32:35], v3 offset:17408
    v_cvt_pk_bf16_f32 v44, v64, v65
    v_cvt_pk_bf16_f32 v45, v66, v67
    v_exp_f32 v69, v69
    v_exp_f32 v70, v70
    v_mfma_f32_32x32x16_bf16 v[140:155], v[40:43], v[48:51], v[140:155]
    s_waitcnt lgkmcnt(2)
    ds_read_b128 v[40:43], v3 offset:15360
    v_exp_f32 v71, v71
    v_cvt_pk_bf16_f32 v46, v68, v69
    v_exp_f32 v72, v72
    v_cvt_pk_bf16_f32 v47, v70, v71
    v_exp_f32 v73, v73
    v_exp_f32 v74, v74
    v_mfma_f32_32x32x16_bf16 v[96:111], v[36:39], v[44:47], v[96:111]
    s_waitcnt lgkmcnt(2)
    v_exp_f32 v75, v75
    v_cvt_pk_bf16_f32 v48, v72, v73
    v_exp_f32 v76, v76
    v_cvt_pk_bf16_f32 v49, v74, v75
    v_exp_f32 v77, v77
    v_exp_f32 v60, v78
    v_exp_f32 v61, v79
    v_cvt_pk_bf16_f32 v50, v76, v77
    v_mfma_f32_32x32x16_bf16 v[64:79], v[28:31], v[16:19], v[112:127]
    v_cvt_pk_bf16_f32 v51, v60, v61
    v_exp_f32 v80, v80
    v_exp_f32 v81, v81
    v_exp_f32 v82, v82
    v_smfmac_f32_16x16x64_bf16 v[52:55], v[24:27], v[44:51], v62
    s_waitcnt lgkmcnt(1)
    v_exp_f32 v83, v83
    v_exp_f32 v84, v84
    v_mfma_f32_32x32x16_bf16 v[64:79], v[32:35], v[20:23], v[64:79]
    s_waitcnt lgkmcnt(0)
    v_cvt_pk_bf16_f32 v44, v80, v81
    v_cvt_pk_bf16_f32 v45, v82, v83
    v_exp_f32 v85, v85
    v_exp_f32 v86, v86
    v_mfma_f32_32x32x16_bf16 v[96:111], v[40:43], v[48:51], v[96:111]
    v_exp_f32 v87, v87
    v_cvt_pk_bf16_f32 v46, v84, v85
    v_exp_f32 v88, v88
    v_cvt_pk_bf16_f32 v47, v86, v87
    v_exp_f32 v89, v89
    v_exp_f32 v90, v90
    v_mfma_f32_32x32x16_bf16 v[140:155], v[36:39], v[44:47], v[140:155]
    ds_read_b128 v[36:39], v3 offset:18432
    v_exp_f32 v91, v91
    v_cvt_pk_bf16_f32 v48, v88, v89
    v_exp_f32 v92, v92
    v_cvt_pk_bf16_f32 v49, v90, v91
    v_exp_f32 v93, v93
    v_exp_f32 v60, v94
    v_exp_f32 v61, v95
    v_cvt_pk_bf16_f32 v50, v92, v93
    v_mfma_f32_32x32x16_bf16 v[80:95], v[28:31], v[128:131], v[156:171]
    ds_read_b128 v[28:31], v3 offset:20480
    v_cvt_pk_bf16_f32 v51, v60, v61
    v_exp_f32 v64, v64
    v_exp_f32 v65, v65
    v_exp_f32 v66, v66
    v_smfmac_f32_16x16x64_bf16 v[56:59], v[24:27], v[44:51], v62
    v_exp_f32 v67, v67
    v_exp_f32 v68, v68
    v_mfma_f32_32x32x16_bf16 v[80:95], v[32:35], v[132:135], v[80:95]
    ds_read_b128 v[32:35], v3 offset:21504
    v_cvt_pk_bf16_f32 v44, v64, v65
    v_cvt_pk_bf16_f32 v45, v66, v67
    v_exp_f32 v69, v69
    v_exp_f32 v70, v70
    v_mfma_f32_32x32x16_bf16 v[140:155], v[40:43], v[48:51], v[140:155]
    s_waitcnt lgkmcnt(2)
    ds_read_b128 v[40:43], v3 offset:19456
    v_exp_f32 v71, v71
    v_cvt_pk_bf16_f32 v46, v68, v69
    v_exp_f32 v72, v72
    v_cvt_pk_bf16_f32 v47, v70, v71
    v_exp_f32 v73, v73
    v_exp_f32 v74, v74
    v_mfma_f32_32x32x16_bf16 v[96:111], v[36:39], v[44:47], v[96:111]
    s_waitcnt lgkmcnt(2)
    v_exp_f32 v75, v75
    v_cvt_pk_bf16_f32 v48, v72, v73
    v_exp_f32 v76, v76
    v_cvt_pk_bf16_f32 v49, v74, v75
    v_exp_f32 v77, v77
    v_exp_f32 v60, v78
    v_exp_f32 v61, v79
    v_cvt_pk_bf16_f32 v50, v76, v77
    v_mfma_f32_32x32x16_bf16 v[64:79], v[28:31], v[16:19], v[112:127]
    v_cvt_pk_bf16_f32 v51, v60, v61
    v_exp_f32 v80, v80
    v_exp_f32 v81, v81
    v_exp_f32 v82, v82
    v_smfmac_f32_16x16x64_bf16 v[52:55], v[24:27], v[44:51], v62
    s_waitcnt lgkmcnt(1)
    v_exp_f32 v83, v83
    v_exp_f32 v84, v84
    v_mfma_f32_32x32x16_bf16 v[64:79], v[32:35], v[20:23], v[64:79]
    s_waitcnt lgkmcnt(0)
    v_cvt_pk_bf16_f32 v44, v80, v81
    v_cvt_pk_bf16_f32 v45, v82, v83
    v_exp_f32 v85, v85
    v_exp_f32 v86, v86
    v_mfma_f32_32x32x16_bf16 v[96:111], v[40:43], v[48:51], v[96:111]
    v_exp_f32 v87, v87
    v_cvt_pk_bf16_f32 v46, v84, v85
    v_exp_f32 v88, v88
    v_cvt_pk_bf16_f32 v47, v86, v87
    v_exp_f32 v89, v89
    v_exp_f32 v90, v90
    v_mfma_f32_32x32x16_bf16 v[140:155], v[36:39], v[44:47], v[140:155]
    ds_read_b128 v[36:39], v3 offset:22528
    v_exp_f32 v91, v91
    v_cvt_pk_bf16_f32 v48, v88, v89
    v_exp_f32 v92, v92
    v_cvt_pk_bf16_f32 v49, v90, v91
    v_exp_f32 v93, v93
    v_exp_f32 v60, v94
    v_exp_f32 v61, v95
    v_cvt_pk_bf16_f32 v50, v92, v93
    v_mfma_f32_32x32x16_bf16 v[80:95], v[28:31], v[128:131], v[156:171]
    ds_read_b128 v[28:31], v3 offset:24576
    v_cvt_pk_bf16_f32 v51, v60, v61
    v_exp_f32 v64, v64
    v_exp_f32 v65, v65
    v_exp_f32 v66, v66
    v_smfmac_f32_16x16x64_bf16 v[56:59], v[24:27], v[44:51], v62
    v_exp_f32 v67, v67
    v_exp_f32 v68, v68
    v_mfma_f32_32x32x16_bf16 v[80:95], v[32:35], v[132:135], v[80:95]
    ds_read_b128 v[32:35], v3 offset:25600
    v_cvt_pk_bf16_f32 v44, v64, v65
    v_cvt_pk_bf16_f32 v45, v66, v67
    v_exp_f32 v69, v69
    v_exp_f32 v70, v70
    v_mfma_f32_32x32x16_bf16 v[140:155], v[40:43], v[48:51], v[140:155]
    s_waitcnt lgkmcnt(2)
    ds_read_b128 v[40:43], v3 offset:23552
    v_exp_f32 v71, v71
    v_cvt_pk_bf16_f32 v46, v68, v69
    v_exp_f32 v72, v72
    v_cvt_pk_bf16_f32 v47, v70, v71
    v_exp_f32 v73, v73
    v_exp_f32 v74, v74
    v_mfma_f32_32x32x16_bf16 v[96:111], v[36:39], v[44:47], v[96:111]
    s_waitcnt lgkmcnt(2)
    v_exp_f32 v75, v75
    v_cvt_pk_bf16_f32 v48, v72, v73
    v_exp_f32 v76, v76
    v_cvt_pk_bf16_f32 v49, v74, v75
    v_exp_f32 v77, v77
    v_exp_f32 v60, v78
    v_exp_f32 v61, v79
    v_cvt_pk_bf16_f32 v50, v76, v77
    v_mfma_f32_32x32x16_bf16 v[64:79], v[28:31], v[16:19], v[112:127]
    v_cvt_pk_bf16_f32 v51, v60, v61
    v_exp_f32 v80, v80
    v_exp_f32 v81, v81
    v_exp_f32 v82, v82
    v_smfmac_f32_16x16x64_bf16 v[52:55], v[24:27], v[44:51], v62
    s_waitcnt lgkmcnt(1)
    v_exp_f32 v83, v83
    v_exp_f32 v84, v84
    v_mfma_f32_32x32x16_bf16 v[64:79], v[32:35], v[20:23], v[64:79]
    s_waitcnt lgkmcnt(0)
    v_cvt_pk_bf16_f32 v44, v80, v81
    v_cvt_pk_bf16_f32 v45, v82, v83
    v_exp_f32 v85, v85
    v_exp_f32 v86, v86
    v_mfma_f32_32x32x16_bf16 v[96:111], v[40:43], v[48:51], v[96:111]
    v_exp_f32 v87, v87
    v_cvt_pk_bf16_f32 v46, v84, v85
    v_exp_f32 v88, v88
    v_cvt_pk_bf16_f32 v47, v86, v87
    v_exp_f32 v89, v89
    v_exp_f32 v90, v90
    v_mfma_f32_32x32x16_bf16 v[140:155], v[36:39], v[44:47], v[140:155]
    ds_read_b128 v[36:39], v3 offset:26624
    v_exp_f32 v91, v91
    v_cvt_pk_bf16_f32 v48, v88, v89
    v_exp_f32 v92, v92
    v_cvt_pk_bf16_f32 v49, v90, v91
    v_exp_f32 v93, v93
    v_exp_f32 v60, v94
    v_exp_f32 v61, v95
    v_cvt_pk_bf16_f32 v50, v92, v93
    v_mfma_f32_32x32x16_bf16 v[80:95], v[28:31], v[128:131], v[156:171]
    ds_read_b128 v[28:31], v3 offset:28672
    v_cvt_pk_bf16_f32 v51, v60, v61
    v_exp_f32 v64, v64
    v_exp_f32 v65, v65
    v_exp_f32 v66, v66
    v_smfmac_f32_16x16x64_bf16 v[56:59], v[24:27], v[44:51], v62
    v_exp_f32 v67, v67
    v_exp_f32 v68, v68
    v_mfma_f32_32x32x16_bf16 v[80:95], v[32:35], v[132:135], v[80:95]
    ds_read_b128 v[32:35], v3 offset:29696
    v_cvt_pk_bf16_f32 v44, v64, v65
    v_cvt_pk_bf16_f32 v45, v66, v67
    v_exp_f32 v69, v69
    v_exp_f32 v70, v70
    v_mfma_f32_32x32x16_bf16 v[140:155], v[40:43], v[48:51], v[140:155]
    s_waitcnt lgkmcnt(2)
    ds_read_b128 v[40:43], v3 offset:27648
    v_exp_f32 v71, v71
    v_cvt_pk_bf16_f32 v46, v68, v69
    v_exp_f32 v72, v72
    v_cvt_pk_bf16_f32 v47, v70, v71
    v_exp_f32 v73, v73
    v_exp_f32 v74, v74
    v_mfma_f32_32x32x16_bf16 v[96:111], v[36:39], v[44:47], v[96:111]
    s_waitcnt lgkmcnt(2)
    v_exp_f32 v75, v75
    v_cvt_pk_bf16_f32 v48, v72, v73
    v_exp_f32 v76, v76
    v_cvt_pk_bf16_f32 v49, v74, v75
    v_exp_f32 v77, v77
    v_exp_f32 v60, v78
    v_exp_f32 v61, v79
    v_cvt_pk_bf16_f32 v50, v76, v77
    v_mfma_f32_32x32x16_bf16 v[64:79], v[28:31], v[16:19], v[112:127]
    s_barrier
    v_cvt_pk_bf16_f32 v51, v60, v61
    v_exp_f32 v80, v80
    v_exp_f32 v81, v81
    v_exp_f32 v82, v82
    v_smfmac_f32_16x16x64_bf16 v[52:55], v[24:27], v[44:51], v62
    s_waitcnt lgkmcnt(1)
    v_exp_f32 v83, v83
    v_exp_f32 v84, v84
    v_mfma_f32_32x32x16_bf16 v[64:79], v[32:35], v[20:23], v[64:79]
    s_waitcnt lgkmcnt(0)
    v_cvt_pk_bf16_f32 v44, v80, v81
    v_cvt_pk_bf16_f32 v45, v82, v83
    v_exp_f32 v85, v85
    v_exp_f32 v86, v86
    v_mfma_f32_32x32x16_bf16 v[96:111], v[40:43], v[48:51], v[96:111]
    v_exp_f32 v87, v87
    v_cvt_pk_bf16_f32 v46, v84, v85
    v_exp_f32 v88, v88
    v_cvt_pk_bf16_f32 v47, v86, v87
    v_exp_f32 v89, v89
    v_exp_f32 v90, v90
    v_mfma_f32_32x32x16_bf16 v[140:155], v[36:39], v[44:47], v[140:155]
    ds_read_b128 v[36:39], v3 offset:30720
    v_exp_f32 v91, v91
    v_cvt_pk_bf16_f32 v48, v88, v89
    v_exp_f32 v92, v92
    v_cvt_pk_bf16_f32 v49, v90, v91
    v_exp_f32 v93, v93
    v_exp_f32 v60, v94
    v_exp_f32 v61, v95
    v_cvt_pk_bf16_f32 v50, v92, v93
    v_mfma_f32_32x32x16_bf16 v[80:95], v[28:31], v[128:131], v[156:171]
    ds_read_b128 v[28:31], v4 offset:0
    v_cvt_pk_bf16_f32 v51, v60, v61
    v_exp_f32 v64, v64
    v_exp_f32 v65, v65
    v_exp_f32 v66, v66
    v_smfmac_f32_16x16x64_bf16 v[56:59], v[24:27], v[44:51], v62
    v_exp_f32 v67, v67
    v_exp_f32 v68, v68
    v_mfma_f32_32x32x16_bf16 v[80:95], v[32:35], v[132:135], v[80:95]
    ds_read_b128 v[32:35], v4 offset:1024
    v_cvt_pk_bf16_f32 v44, v64, v65
    v_cvt_pk_bf16_f32 v45, v66, v67
    v_exp_f32 v69, v69
    v_exp_f32 v70, v70
    v_mfma_f32_32x32x16_bf16 v[140:155], v[40:43], v[48:51], v[140:155]
    s_waitcnt lgkmcnt(2)
    ds_read_b128 v[40:43], v3 offset:31744
    v_exp_f32 v71, v71
    v_cvt_pk_bf16_f32 v46, v68, v69
    v_exp_f32 v72, v72
    v_cvt_pk_bf16_f32 v47, v70, v71
    v_exp_f32 v73, v73
    v_exp_f32 v74, v74
    v_mfma_f32_32x32x16_bf16 v[96:111], v[36:39], v[44:47], v[96:111]
    s_waitcnt lgkmcnt(2)
    v_exp_f32 v75, v75
    v_cvt_pk_bf16_f32 v48, v72, v73
    v_exp_f32 v76, v76
    v_cvt_pk_bf16_f32 v49, v74, v75
    v_exp_f32 v77, v77
    v_exp_f32 v60, v78
    v_exp_f32 v61, v79
    v_cvt_pk_bf16_f32 v50, v76, v77
    v_mfma_f32_32x32x16_bf16 v[64:79], v[28:31], v[16:19], v[112:127]
    s_add_u32 s35, s35, 2
    v_cvt_pk_bf16_f32 v51, v60, v61
    v_exp_f32 v80, v80
    v_exp_f32 v81, v81
    v_exp_f32 v82, v82
    v_smfmac_f32_16x16x64_bf16 v[52:55], v[24:27], v[44:51], v62
    s_waitcnt lgkmcnt(1)
    s_cmp_lt_u32 s35, s33
    v_exp_f32 v83, v83
    v_exp_f32 v84, v84
    v_mfma_f32_32x32x16_bf16 v[64:79], v[32:35], v[20:23], v[64:79]
    s_waitcnt lgkmcnt(0)
    v_cvt_pk_bf16_f32 v44, v80, v81
    v_cvt_pk_bf16_f32 v45, v82, v83
    v_exp_f32 v85, v85
    v_exp_f32 v86, v86
    v_mfma_f32_32x32x16_bf16 v[96:111], v[40:43], v[48:51], v[96:111]
    v_exp_f32 v87, v87
    v_cvt_pk_bf16_f32 v46, v84, v85
    v_exp_f32 v88, v88
    v_cvt_pk_bf16_f32 v47, v86, v87
    v_exp_f32 v89, v89
    v_exp_f32 v90, v90
    v_mfma_f32_32x32x16_bf16 v[140:155], v[36:39], v[44:47], v[140:155]
    ds_read_b128 v[36:39], v4 offset:2048
    v_exp_f32 v91, v91
    v_cvt_pk_bf16_f32 v48, v88, v89
    v_exp_f32 v92, v92
    v_cvt_pk_bf16_f32 v49, v90, v91
    v_exp_f32 v93, v93
    v_exp_f32 v60, v94
    v_exp_f32 v61, v95
    v_cvt_pk_bf16_f32 v50, v92, v93
    v_swap_b32 v3, v4
    v_mfma_f32_32x32x16_bf16 v[80:95], v[28:31], v[128:131], v[156:171]
    s_cbranch_scc1 K2_LOOP
    s_cmp_eq_u32 s35, 16
    s_cbranch_scc1 K2_DONE
    s_add_u32 s68, s29, 12632064
    s_add_u32 s69, s68, 65792
    s_lshl_b32 s70, s24, 12
    s_add_u32 s70, s70, 18219008
    s_mov_b32 s71, 1
    s_mov_b32 s33, 16
    s_cmp_eq_u64 s[92:93], 0
    s_cbranch_scc1 K2_LOOP
    s_waitcnt vmcnt(0)
    v_mov_b32 v173, 1
    s_mov_b64 exec, s[92:93]
    buffer_atomic_add v173, v172, s[16:19], s74 offen offset:0 sc1
    s_mov_b64 exec, -1
    s_branch K2_LOOP
K2_DONE:
    v_cvt_pk_bf16_f32 v51, v60, v61
    v_add_f32 v52, v52, v53
    s_nop 0
    v_mfma_f32_32x32x16_bf16 v[140:155], v[40:43], v[48:51], v[140:155]
    v_smfmac_f32_16x16x64_bf16 v[56:59], v[24:27], v[44:51], v62
K2_FIN:
    v_rcp_f32 v8, v52
    s_nop 0
    v_mul_f32 v96, v96, v8
    v_mul_f32 v97, v97, v8
    v_cvt_pk_bf16_f32 v176, v96, v97
    v_mul_f32 v98, v98, v8
    v_mul_f32 v99, v99, v8
    v_cvt_pk_bf16_f32 v177, v98, v99
    v_mul_f32 v100, v100, v8
    v_mul_f32 v101, v101, v8
    v_cvt_pk_bf16_f32 v178, v100, v101
    v_mul_f32 v102, v102, v8
    v_mul_f32 v103, v103, v8
    v_cvt_pk_bf16_f32 v179, v102, v103
    buffer_store_dwordx4 v[176:179], v1, s[16:19], s68 offen offset:0 sc1
    v_mul_f32 v104, v104, v8
    v_mul_f32 v105, v105, v8
    v_cvt_pk_bf16_f32 v180, v104, v105
    v_mul_f32 v106, v106, v8
    v_mul_f32 v107, v107, v8
    v_cvt_pk_bf16_f32 v181, v106, v107
    v_mul_f32 v108, v108, v8
    v_mul_f32 v109, v109, v8
    v_cvt_pk_bf16_f32 v182, v108, v109
    v_mul_f32 v110, v110, v8
    v_mul_f32 v111, v111, v8
    v_cvt_pk_bf16_f32 v183, v110, v111
    buffer_store_dwordx4 v[180:183], v1, s[16:19], s68 offen offset:1024 sc1
    v_add_f32 v56, v56, v57
    v_rcp_f32 v8, v56
    s_nop 0
    v_mul_f32 v140, v140, v8
    v_mul_f32 v141, v141, v8
    v_cvt_pk_bf16_f32 v184, v140, v141
    v_mul_f32 v142, v142, v8
    v_mul_f32 v143, v143, v8
    v_cvt_pk_bf16_f32 v185, v142, v143
    v_mul_f32 v144, v144, v8
    v_mul_f32 v145, v145, v8
    v_cvt_pk_bf16_f32 v186, v144, v145
    v_mul_f32 v146, v146, v8
    v_mul_f32 v147, v147, v8
    v_cvt_pk_bf16_f32 v187, v146, v147
    buffer_store_dwordx4 v[184:187], v1, s[16:19], s69 offen offset:0 sc1
    v_mul_f32 v148, v148, v8
    v_mul_f32 v149, v149, v8
    v_cvt_pk_bf16_f32 v188, v148, v149
    v_mul_f32 v150, v150, v8
    v_mul_f32 v151, v151, v8
    v_cvt_pk_bf16_f32 v189, v150, v151
    v_mul_f32 v152, v152, v8
    v_mul_f32 v153, v153, v8
    v_cvt_pk_bf16_f32 v190, v152, v153
    v_mul_f32 v154, v154, v8
    v_mul_f32 v155, v155, v8
    v_cvt_pk_bf16_f32 v191, v154, v155
    buffer_store_dwordx4 v[188:191], v1, s[16:19], s69 offen offset:1024 sc1
    s_cmp_eq_u32 s71, 0
    s_cbranch_scc1 K2_OK
    v_mov_b32 v10, 0x7f800000
    v_mov_b32 v11, 0x5d800000
    v_add_f32 v8, |v96|, |v97|
    v_mov_b32 v9, 0
    v_add_f32 v8, v8, |v98|
    v_add_f32 v9, v9, |v99|
    v_add_f32 v8, v8, |v100|
    v_add_f32 v9, v9, |v101|
    v_add_f32 v8, v8, |v102|
    v_add_f32 v9, v9, |v103|
    v_add_f32 v8, v8, |v104|
    v_add_f32 v9, v9, |v105|
    v_add_f32 v8, v8, |v106|
    v_add_f32 v9, v9, |v107|
    v_add_f32 v8, v8, |v108|
    v_add_f32 v9, v9, |v109|
    v_add_f32 v8, v8, |v110|
    v_add_f32 v9, v9, |v111|
    v_add_f32 v8, v8, |v140|
    v_add_f32 v9, v9, |v141|
    v_add_f32 v8, v8, |v142|
    v_add_f32 v9, v9, |v143|
    v_add_f32 v8, v8, |v144|
    v_add_f32 v9, v9, |v145|
    v_add_f32 v8, v8, |v146|
    v_add_f32 v9, v9, |v147|
    v_add_f32 v8, v8, |v148|
    v_add_f32 v9, v9, |v149|
    v_add_f32 v8, v8, |v150|
    v_add_f32 v9, v9, |v151|
    v_add_f32 v8, v8, |v152|
    v_add_f32 v9, v9, |v153|
    v_add_f32 v8, v8, |v154|
    v_add_f32 v9, v9, |v155|
    v_cmp_nlt_f32 vcc, v52, v11
    v_cmp_nlt_f32 s[72:73], v56, v11
    v_add_f32 v8, v8, v9
    v_cmp_nlt_f32 s[74:75], v8, v10
    s_or_b64 vcc, vcc, s[72:73]
    s_mov_b32 s71, 0
    s_nop 0
    s_or_b64 vcc, vcc, s[74:75]
    s_cbranch_vccnz K2_SLOW
K2_OK:
    s_and_b32 s89, s20, 3
    s_lshl_b32 s89, s89, 2
    s_and_b32 s25, s21, 3
    s_add_u32 s89, s89, s25
    s_lshr_b32 s90, s20, 2
    s_lshl_b32 s90, s90, 3
    s_lshr_b32 s25, s21, 2
    s_add_u32 s90, s90, s25
    s_lshl_b32 s91, s89, 4
    s_add_u32 s91, s91, s90
    s_lshl_b32 s91, s91, 7
    s_add_u32 s91, s91, 18219008
    s_mov_b32 s4, s54
    s_and_b32 s5, s55, 0xffff
    s_mov_b32 s6, 2097152
    s_mov_b32 s7, 0x20000
    v_and_b32 v5, 7, v2
    v_bfe_u32 v4, v2, 4, 2
    v_lshlrev_b32 v4, 1, v4
    v_xor_b32 v4, v4, v5
    s_lshl_b32 s25, s90, 7
    v_lshl_add_u32 v4, v4, 4, s25
    v_lshrrev_b32 v5, 3, v2
    v_lshl_add_u32 v236, v5, 11, v4
    s_lshl_b32 s76, s26, 14
    s_and_b32 s78, s90, 0
    s_lshl_b32 s78, s78, 1
    s_lshl_b32 s25, s78, 17
    s_add_u32 s76, s76, s25
    s_lshl_b32 s78, s78, 12
    s_lshl_b32 s80, s26, 10
    s_mov_b32 s8, s56
    s_and_b32 s9, s57, 0xffff
    s_mov_b32 s10, 8388608
    s_mov_b32 s11, 0x20000
    v_lshrrev_b32 v4, 5, v2
    v_bfe_u32 v5, v2, 2, 3
    v_lshl_add_u32 v6, v4, 4, v5
    v_and_b32 v5, 6, v5
    v_lshlrev_b32 v5, 4, v5
    v_and_b32 v7, 3, v2
    v_lshl_add_u32 v5, v7, 3, v5
    v_lshl_add_u32 v240, v6, 7, v5
    v_xor_b32 v241, 32, v240
    v_xor_b32 v242, 64, v240
    v_xor_b32 v243, 96, v240
    v_and_b32 v5, 15, v2
    v_lshrrev_b32 v6, 4, v2
    v_lshlrev_b32 v7, 4, v5
    v_lshl_add_u32 v244, v6, 9, v7
    s_lshl_b32 s25, s26, 12
    s_add_u32 s25, s25, 65536
    v_and_b32 v7, 7, v2
    v_lshl_add_u32 v5, v5, 7, s25
    v_and_b32 v6, 1, v6
    v_lshl_add_u32 v5, v6, 3, v5
    v_xor_b32 v6, v7, v4
    v_lshl_add_u32 v246, v6, 4, v5
    v_xor_b32 v247, 32, v246
    v_xor_b32 v248, 64, v246
    v_xor_b32 v249, 96, v246
    v_lshrrev_b32 v5, 3, v2
    v_xor_b32 v6, v5, v7
    v_lshl_add_u32 v250, v5, 7, s25
    v_lshl_add_u32 v250, v6, 4, v250
    v_lshlrev_b32 v5, 12, v5
    v_lshl_add_u32 v251, v7, 4, v5
    s_lshl_b32 s25, s89, 2
    s_add_u32 s25, s25, s26
    s_lshl_b32 s72, s25, 17
    s_lshl_b32 s27, s90, 7
    s_add_u32 s72, s72, s27
    s_add_u32 s72, s72, 2048
    s_mul_i32 s77, s25, 65792
    s_add_u32 s77, s77, 12632064
    s_add_u32 s71, s77, s78
    s_mov_b32 s73, 90112
    v_mov_b32 v204, 0
    v_mov_b32 v205, 0
    v_mov_b32 v206, 0
    v_mov_b32 v207, 0
    v_mov_b32 v208, 0
    v_mov_b32 v209, 0
    v_mov_b32 v210, 0
    v_mov_b32 v211, 0
    v_mov_b32 v212, 0
    v_mov_b32 v213, 0
    v_mov_b32 v214, 0
    v_mov_b32 v215, 0
    v_mov_b32 v216, 0
    v_mov_b32 v217, 0
    v_mov_b32 v218, 0
    v_mov_b32 v219, 0
    v_mov_b32 v220, 0
    v_mov_b32 v221, 0
    v_mov_b32 v222, 0
    v_mov_b32 v223, 0
    v_mov_b32 v224, 0
    v_mov_b32 v225, 0
    v_mov_b32 v226, 0
    v_mov_b32 v227, 0
    v_mov_b32 v228, 0
    v_mov_b32 v229, 0
    v_mov_b32 v230, 0
    v_mov_b32 v231, 0
    v_mov_b32 v232, 0
    v_mov_b32 v233, 0
    v_mov_b32 v234, 0
    v_mov_b32 v235, 0
    v_lshlrev_b32 v10, 7, v2
    v_mov_b32 v8, 159752
    v_mov_b32 v9, 1
    s_mov_b64 exec, 1
    s_waitcnt vmcnt(0)
    ds_add_rtn_u32 v8, v8, v9
    s_waitcnt lgkmcnt(0)
    v_readfirstlane_b32 s96, v8
    s_mov_b32 exec_lo, -1
    s_cmp_eq_u32 s96, 3
    s_cbranch_scc0 SIG_23
    buffer_atomic_add v9, v10, s[16:19], s70 offen offset:4 sc1
SIG_23:
    s_mov_b64 exec, -1
    s_waitcnt lgkmcnt(0)
    s_barrier
    s_add_u32 m0, s80, 0
    s_add_u32 s25, s76, 0
    s_and_b32 s25, s25, 2097151
    buffer_load_dwordx4 v236, s[4:7], s25 offen lds
    s_add_u32 m0, s80, 4096
    s_add_u32 s25, s76, 65536
    s_and_b32 s25, s25, 2097151
    buffer_load_dwordx4 v236, s[4:7], s25 offen lds
    s_add_u32 m0, s80, 8192
    s_add_u32 s25, s76, 131072
    s_and_b32 s25, s25, 2097151
    buffer_load_dwordx4 v236, s[4:7], s25 offen lds
    s_add_u32 m0, s80, 12288
    s_add_u32 s25, s76, 196608
    s_and_b32 s25, s25, 2097151
    buffer_load_dwordx4 v236, s[4:7], s25 offen lds
    s_add_u32 m0, s80, 16384
    s_add_u32 s25, s76, 262144
    s_and_b32 s25, s25, 2097151
    buffer_load_dwordx4 v236, s[4:7], s25 offen lds
    s_add_u32 m0, s80, 20480
    s_add_u32 s25, s76, 327680
    s_and_b32 s25, s25, 2097151
    buffer_load_dwordx4 v236, s[4:7], s25 offen lds
    s_add_u32 m0, s80, 24576
    s_add_u32 s25, s76, 393216
    s_and_b32 s25, s25, 2097151
    buffer_load_dwordx4 v236, s[4:7], s25 offen lds
    s_add_u32 m0, s80, 28672
    s_add_u32 s25, s76, 458752
    s_and_b32 s25, s25, 2097151
    buffer_load_dwordx4 v236, s[4:7], s25 offen lds
    s_add_u32 m0, s80, 32768
    s_add_u32 s25, s76, 524288
    s_and_b32 s25, s25, 2097151
    buffer_load_dwordx4 v236, s[4:7], s25 offen lds
    s_add_u32 m0, s80, 36864
    s_add_u32 s25, s76, 589824
    s_and_b32 s25, s25, 2097151
    buffer_load_dwordx4 v236, s[4:7], s25 offen lds
    s_add_u32 m0, s80, 40960
    s_add_u32 s25, s76, 655360
    s_and_b32 s25, s25, 2097151
    buffer_load_dwordx4 v236, s[4:7], s25 offen lds
    s_add_u32 m0, s80, 45056
    s_add_u32 s25, s76, 720896
    s_and_b32 s25, s25, 2097151
    buffer_load_dwordx4 v236, s[4:7], s25 offen lds
    s_add_u32 m0, s80, 49152
    s_add_u32 s25, s76, 786432
    s_and_b32 s25, s25, 2097151
    buffer_load_dwordx4 v236, s[4:7], s25 offen lds
    s_add_u32 m0, s80, 53248
    s_add_u32 s25, s76, 851968
    s_and_b32 s25, s25, 2097151
    buffer_load_dwordx4 v236, s[4:7], s25 offen lds
    s_add_u32 m0, s80, 57344
    s_add_u32 s25, s76, 917504
    s_and_b32 s25, s25, 2097151
    buffer_load_dwordx4 v236, s[4:7], s25 offen lds
    s_add_u32 m0, s80, 61440
    s_add_u32 s25, s76, 983040
    s_and_b32 s25, s25, 2097151
    buffer_load_dwordx4 v236, s[4:7], s25 offen lds
    s_add_u32 m0, s80, 131072
    s_add_u32 s25, s76, 1703936
    s_and_b32 s25, s25, 2097151
    buffer_load_dwordx4 v236, s[4:7], s25 offen lds
    s_add_u32 m0, s80, 135168
    s_add_u32 s25, s76, 1769472
    s_and_b32 s25, s25, 2097151
    buffer_load_dwordx4 v236, s[4:7], s25 offen lds
    s_add_u32 m0, s80, 139264
    s_add_u32 s25, s76, 1835008
    s_and_b32 s25, s25, 2097151
    buffer_load_dwordx4 v236, s[4:7], s25 offen lds
    s_add_u32 m0, s80, 143360
    s_add_u32 s25, s76, 1900544
    s_and_b32 s25, s25, 2097151
    buffer_load_dwordx4 v236, s[4:7], s25 offen lds
    s_add_u32 m0, s80, 147456
    s_add_u32 s25, s76, 1966080
    s_and_b32 s25, s25, 2097151
    buffer_load_dwordx4 v236, s[4:7], s25 offen lds
    s_add_u32 m0, s80, 151552
    s_add_u32 s25, s76, 2031616
    s_and_b32 s25, s25, 2097151
    buffer_load_dwordx4 v236, s[4:7], s25 offen lds
    s_cmp_eq_u32 s22, 0
    s_cbranch_scc0 K3_NP
    s_add_u32 s27, s91, 4
    s_mov_b32 s96, 300000
    v_mov_b32 v9, 0
POLL_24:
    buffer_load_dword v8, v9, s[16:19], s27 offen sc1
    s_waitcnt vmcnt(0)
    v_cmp_gt_u32 vcc, 32, v8
    s_sub_u32 s96, s96, 1
    s_cbranch_vccz POLLD_25
    s_sleep 1
    s_cmp_lg_u32 s96, 0
    s_cbranch_scc1 POLL_24
POLLD_25:
K3_NP:
    s_waitcnt vmcnt(0)
    s_barrier
    buffer_load_dwordx4 v[12:15], v244, s[16:19], s71 offen offset:0 sc1
    buffer_load_dwordx4 v[16:19], v244, s[16:19], s71 offen offset:256 sc1
    buffer_load_dwordx4 v[20:23], v244, s[16:19], s71 offen offset:2048 sc1
    buffer_load_dwordx4 v[24:27], v244, s[16:19], s71 offen offset:2304 sc1
    s_add_u32 s78, s78, 4096
    s_and_b32 s78, s78, 0xffff
    s_add_u32 s71, s77, s78
    buffer_load_dwordx4 v[28:31], v244, s[16:19], s71 offen offset:0 sc1
    buffer_load_dwordx4 v[32:35], v244, s[16:19], s71 offen offset:256 sc1
    buffer_load_dwordx4 v[36:39], v244, s[16:19], s71 offen offset:2048 sc1
    buffer_load_dwordx4 v[40:43], v244, s[16:19], s71 offen offset:2304 sc1
    s_add_u32 s78, s78, 4096
    s_and_b32 s78, s78, 0xffff
    s_add_u32 s71, s77, s78
    buffer_load_dwordx4 v[44:47], v244, s[16:19], s71 offen offset:0 sc1
    buffer_load_dwordx4 v[48:51], v244, s[16:19], s71 offen offset:256 sc1
    buffer_load_dwordx4 v[52:55], v244, s[16:19], s71 offen offset:2048 sc1
    buffer_load_dwordx4 v[56:59], v244, s[16:19], s71 offen offset:2304 sc1
    s_add_u32 s78, s78, 4096
    s_and_b32 s78, s78, 0xffff
    s_add_u32 s71, s77, s78
    ds_read_b64_tr_b16 v[172:173], v240 offset:0
    ds_read_b64_tr_b16 v[174:175], v240 offset:1024
    ds_read_b64_tr_b16 v[176:177], v241 offset:0
    ds_read_b64_tr_b16 v[178:179], v241 offset:1024
    ds_read_b64_tr_b16 v[180:181], v242 offset:0
    ds_read_b64_tr_b16 v[182:183], v242 offset:1024
    ds_read_b64_tr_b16 v[184:185], v243 offset:0
    ds_read_b64_tr_b16 v[186:187], v243 offset:1024
    ds_read_b64_tr_b16 v[188:189], v240 offset:4096
    ds_read_b64_tr_b16 v[190:191], v240 offset:5120
    ds_read_b64_tr_b16 v[192:193], v241 offset:4096
    ds_read_b64_tr_b16 v[194:195], v241 offset:5120
    ds_read_b64_tr_b16 v[196:197], v242 offset:4096
    ds_read_b64_tr_b16 v[198:199], v242 offset:5120
    ds_read_b64_tr_b16 v[200:201], v243 offset:4096
    ds_read_b64_tr_b16 v[202:203], v243 offset:5120
    s_waitcnt vmcnt(10)
    s_waitcnt lgkmcnt(14)
    v_mfma_f32_16x16x32_bf16 v[204:207], v[172:175], v[12:15], v[204:207]
    v_mfma_f32_16x16x32_bf16 v[220:223], v[172:175], v[16:19], v[220:223]
    s_waitcnt lgkmcnt(12)
    ds_read_b64_tr_b16 v[172:173], v240 offset:8192
    v_mfma_f32_16x16x32_bf16 v[208:211], v[176:179], v[12:15], v[208:211]
    ds_read_b64_tr_b16 v[174:175], v240 offset:9216
    v_mfma_f32_16x16x32_bf16 v[224:227], v[176:179], v[16:19], v[224:227]
    s_waitcnt lgkmcnt(12)
    ds_read_b64_tr_b16 v[176:177], v241 offset:8192
    v_mfma_f32_16x16x32_bf16 v[212:215], v[180:183], v[12:15], v[212:215]
    ds_read_b64_tr_b16 v[178:179], v241 offset:9216
    s_add_u32 m0, s80, 90112
    s_add_u32 s25, s76, 1048576
    s_and_b32 s25, s25, 2097151
    buffer_load_dwordx4 v236, s[4:7], s25 offen lds
    s_add_u32 m0, s80, 94208
    s_add_u32 s25, s76, 1114112
    s_and_b32 s25, s25, 2097151
    buffer_load_dwordx4 v236, s[4:7], s25 offen lds
    v_mfma_f32_16x16x32_bf16 v[228:231], v[180:183], v[16:19], v[228:231]
    s_waitcnt lgkmcnt(12)
    ds_read_b64_tr_b16 v[180:181], v242 offset:8192
    v_mfma_f32_16x16x32_bf16 v[216:219], v[184:187], v[12:15], v[216:219]
    ds_read_b64_tr_b16 v[182:183], v242 offset:9216
    v_mfma_f32_16x16x32_bf16 v[232:235], v[184:187], v[16:19], v[232:235]
    s_waitcnt lgkmcnt(12)
    s_waitcnt vmcnt(10)
    ds_read_b64_tr_b16 v[184:185], v243 offset:8192
    v_mfma_f32_16x16x32_bf16 v[204:207], v[188:191], v[20:23], v[204:207]
    ds_read_b64_tr_b16 v[186:187], v243 offset:9216
    buffer_load_dwordx4 v[60:63], v244, s[16:19], s71 offen offset:0 sc1
    v_mfma_f32_16x16x32_bf16 v[220:223], v[188:191], v[24:27], v[220:223]
    s_waitcnt lgkmcnt(12)
    ds_read_b64_tr_b16 v[188:189], v240 offset:12288
    v_mfma_f32_16x16x32_bf16 v[208:211], v[192:195], v[20:23], v[208:211]
    ds_read_b64_tr_b16 v[190:191], v240 offset:13312
    buffer_load_dwordx4 v[64:67], v244, s[16:19], s71 offen offset:256 sc1
    v_mfma_f32_16x16x32_bf16 v[224:227], v[192:195], v[24:27], v[224:227]
    s_waitcnt lgkmcnt(12)
    ds_read_b64_tr_b16 v[192:193], v241 offset:12288
    v_mfma_f32_16x16x32_bf16 v[212:215], v[196:199], v[20:23], v[212:215]
    ds_read_b64_tr_b16 v[194:195], v241 offset:13312
    v_mfma_f32_16x16x32_bf16 v[228:231], v[196:199], v[24:27], v[228:231]
    s_waitcnt lgkmcnt(12)
    ds_read_b64_tr_b16 v[196:197], v242 offset:12288
    v_mfma_f32_16x16x32_bf16 v[216:219], v[200:203], v[20:23], v[216:219]
    ds_read_b64_tr_b16 v[198:199], v242 offset:13312
    v_mfma_f32_16x16x32_bf16 v[232:235], v[200:203], v[24:27], v[232:235]
    s_waitcnt lgkmcnt(12)
    s_waitcnt vmcnt(10)
    ds_read_b64_tr_b16 v[200:201], v243 offset:12288
    v_mfma_f32_16x16x32_bf16 v[204:207], v[172:175], v[28:31], v[204:207]
    ds_read_b64_tr_b16 v[202:203], v243 offset:13312
    buffer_load_dwordx4 v[68:71], v244, s[16:19], s71 offen offset:2048 sc1
    v_mfma_f32_16x16x32_bf16 v[220:223], v[172:175], v[32:35], v[220:223]
    s_waitcnt lgkmcnt(12)
    ds_read_b64_tr_b16 v[172:173], v240 offset:16384
    v_mfma_f32_16x16x32_bf16 v[208:211], v[176:179], v[28:31], v[208:211]
    ds_read_b64_tr_b16 v[174:175], v240 offset:17408
    buffer_load_dwordx4 v[72:75], v244, s[16:19], s71 offen offset:2304 sc1
    s_add_u32 s78, s78, 4096
    s_and_b32 s78, s78, 0xffff
    s_add_u32 s71, s77, s78
    v_mfma_f32_16x16x32_bf16 v[224:227], v[176:179], v[32:35], v[224:227]
    s_waitcnt lgkmcnt(12)
    ds_read_b64_tr_b16 v[176:177], v241 offset:16384
    v_mfma_f32_16x16x32_bf16 v[212:215], v[180:183], v[28:31], v[212:215]
    ds_read_b64_tr_b16 v[178:179], v241 offset:17408
    s_add_u32 m0, s80, 98304
    s_add_u32 s25, s76, 1179648
    s_and_b32 s25, s25, 2097151
    buffer_load_dwordx4 v236, s[4:7], s25 offen lds
    s_add_u32 m0, s80, 102400
    s_add_u32 s25, s76, 1245184
    s_and_b32 s25, s25, 2097151
    buffer_load_dwordx4 v236, s[4:7], s25 offen lds
    v_mfma_f32_16x16x32_bf16 v[228:231], v[180:183], v[32:35], v[228:231]
    s_waitcnt lgkmcnt(12)
    ds_read_b64_tr_b16 v[180:181], v242 offset:16384
    v_mfma_f32_16x16x32_bf16 v[216:219], v[184:187], v[28:31], v[216:219]
    ds_read_b64_tr_b16 v[182:183], v242 offset:17408
    v_mfma_f32_16x16x32_bf16 v[232:235], v[184:187], v[32:35], v[232:235]
    s_waitcnt lgkmcnt(12)
    s_waitcnt vmcnt(12)
    ds_read_b64_tr_b16 v[184:185], v243 offset:16384
    v_mfma_f32_16x16x32_bf16 v[204:207], v[188:191], v[36:39], v[204:207]
    ds_read_b64_tr_b16 v[186:187], v243 offset:17408
    buffer_load_dwordx4 v[76:79], v244, s[16:19], s71 offen offset:0 sc1
    v_mfma_f32_16x16x32_bf16 v[220:223], v[188:191], v[40:43], v[220:223]
    s_waitcnt lgkmcnt(12)
    ds_read_b64_tr_b16 v[188:189], v240 offset:20480
    v_mfma_f32_16x16x32_bf16 v[208:211], v[192:195], v[36:39], v[208:211]
    ds_read_b64_tr_b16 v[190:191], v240 offset:21504
    buffer_load_dwordx4 v[80:83], v244, s[16:19], s71 offen offset:256 sc1
    v_mfma_f32_16x16x32_bf16 v[224:227], v[192:195], v[40:43], v[224:227]
    s_waitcnt lgkmcnt(12)
    ds_read_b64_tr_b16 v[192:193], v241 offset:20480
    v_mfma_f32_16x16x32_bf16 v[212:215], v[196:199], v[36:39], v[212:215]
    ds_read_b64_tr_b16 v[194:195], v241 offset:21504
    v_mfma_f32_16x16x32_bf16 v[228:231], v[196:199], v[40:43], v[228:231]
    s_waitcnt lgkmcnt(12)
    ds_read_b64_tr_b16 v[196:197], v242 offset:20480
    v_mfma_f32_16x16x32_bf16 v[216:219], v[200:203], v[36:39], v[216:219]
    ds_read_b64_tr_b16 v[198:199], v242 offset:21504
    v_mfma_f32_16x16x32_bf16 v[232:235], v[200:203], v[40:43], v[232:235]
    s_waitcnt lgkmcnt(12)
    s_waitcnt vmcnt(12)
    ds_read_b64_tr_b16 v[200:201], v243 offset:20480
    v_mfma_f32_16x16x32_bf16 v[204:207], v[172:175], v[44:47], v[204:207]
    ds_read_b64_tr_b16 v[202:203], v243 offset:21504
    buffer_load_dwordx4 v[84:87], v244, s[16:19], s71 offen offset:2048 sc1
    v_mfma_f32_16x16x32_bf16 v[220:223], v[172:175], v[48:51], v[220:223]
    s_waitcnt lgkmcnt(12)
    ds_read_b64_tr_b16 v[172:173], v240 offset:24576
    v_mfma_f32_16x16x32_bf16 v[208:211], v[176:179], v[44:47], v[208:211]
    ds_read_b64_tr_b16 v[174:175], v240 offset:25600
    buffer_load_dwordx4 v[88:91], v244, s[16:19], s71 offen offset:2304 sc1
    s_add_u32 s78, s78, 4096
    s_and_b32 s78, s78, 0xffff
    s_add_u32 s71, s77, s78
    v_mfma_f32_16x16x32_bf16 v[224:227], v[176:179], v[48:51], v[224:227]
    s_waitcnt lgkmcnt(12)
    ds_read_b64_tr_b16 v[176:177], v241 offset:24576
    v_mfma_f32_16x16x32_bf16 v[212:215], v[180:183], v[44:47], v[212:215]
    ds_read_b64_tr_b16 v[178:179], v241 offset:25600
    s_add_u32 m0, s80, 106496
    s_add_u32 s25, s76, 1310720
    s_and_b32 s25, s25, 2097151
    buffer_load_dwordx4 v236, s[4:7], s25 offen lds
    s_add_u32 m0, s80, 110592
    s_add_u32 s25, s76, 1376256
    s_and_b32 s25, s25, 2097151
    buffer_load_dwordx4 v236, s[4:7], s25 offen lds
    v_mfma_f32_16x16x32_bf16 v[228:231], v[180:183], v[48:51], v[228:231]
    s_waitcnt lgkmcnt(12)
    ds_read_b64_tr_b16 v[180:181], v242 offset:24576
    v_mfma_f32_16x16x32_bf16 v[216:219], v[184:187], v[44:47], v[216:219]
    ds_read_b64_tr_b16 v[182:183], v242 offset:25600
    v_mfma_f32_16x16x32_bf16 v[232:235], v[184:187], v[48:51], v[232:235]
    s_waitcnt lgkmcnt(12)
    s_waitcnt vmcnt(14)
    ds_read_b64_tr_b16 v[184:185], v243 offset:24576
    v_mfma_f32_16x16x32_bf16 v[204:207], v[188:191], v[52:55], v[204:207]
    ds_read_b64_tr_b16 v[186:187], v243 offset:25600
    buffer_load_dwordx4 v[92:95], v244, s[16:19], s71 offen offset:0 sc1
    v_mfma_f32_16x16x32_bf16 v[220:223], v[188:191], v[56:59], v[220:223]
    s_waitcnt lgkmcnt(12)
    ds_read_b64_tr_b16 v[188:189], v240 offset:28672
    v_mfma_f32_16x16x32_bf16 v[208:211], v[192:195], v[52:55], v[208:211]
    ds_read_b64_tr_b16 v[190:191], v240 offset:29696
    buffer_load_dwordx4 v[96:99], v244, s[16:19], s71 offen offset:256 sc1
    v_mfma_f32_16x16x32_bf16 v[224:227], v[192:195], v[56:59], v[224:227]
    s_waitcnt lgkmcnt(12)
    ds_read_b64_tr_b16 v[192:193], v241 offset:28672
    v_mfma_f32_16x16x32_bf16 v[212:215], v[196:199], v[52:55], v[212:215]
    ds_read_b64_tr_b16 v[194:195], v241 offset:29696
    v_mfma_f32_16x16x32_bf16 v[228:231], v[196:199], v[56:59], v[228:231]
    s_waitcnt lgkmcnt(12)
    ds_read_b64_tr_b16 v[196:197], v242 offset:28672
    v_mfma_f32_16x16x32_bf16 v[216:219], v[200:203], v[52:55], v[216:219]
    ds_read_b64_tr_b16 v[198:199], v242 offset:29696
    v_mfma_f32_16x16x32_bf16 v[232:235], v[200:203], v[56:59], v[232:235]
    s_waitcnt lgkmcnt(12)
    s_waitcnt vmcnt(12)
    ds_read_b64_tr_b16 v[200:201], v243 offset:28672
    v_mfma_f32_16x16x32_bf16 v[204:207], v[172:175], v[60:63], v[204:207]
    ds_read_b64_tr_b16 v[202:203], v243 offset:29696
    buffer_load_dwordx4 v[100:103], v244, s[16:19], s71 offen offset:2048 sc1
    v_mfma_f32_16x16x32_bf16 v[220:223], v[172:175], v[64:67], v[220:223]
    s_waitcnt lgkmcnt(12)
    ds_read_b64_tr_b16 v[172:173], v240 offset:32768
    v_mfma_f32_16x16x32_bf16 v[208:211], v[176:179], v[60:63], v[208:211]
    ds_read_b64_tr_b16 v[174:175], v240 offset:33792
    buffer_load_dwordx4 v[104:107], v244, s[16:19], s71 offen offset:2304 sc1
    s_add_u32 s78, s78, 4096
    s_and_b32 s78, s78, 0xffff
    s_add_u32 s71, s77, s78
    v_mfma_f32_16x16x32_bf16 v[224:227], v[176:179], v[64:67], v[224:227]
    s_waitcnt lgkmcnt(12)
    ds_read_b64_tr_b16 v[176:177], v241 offset:32768
    v_mfma_f32_16x16x32_bf16 v[212:215], v[180:183], v[60:63], v[212:215]
    ds_read_b64_tr_b16 v[178:179], v241 offset:33792
    s_add_u32 m0, s80, 114688
    s_add_u32 s25, s76, 1441792
    s_and_b32 s25, s25, 2097151
    buffer_load_dwordx4 v236, s[4:7], s25 offen lds
    s_add_u32 m0, s80, 118784
    s_add_u32 s25, s76, 1507328
    s_and_b32 s25, s25, 2097151
    buffer_load_dwordx4 v236, s[4:7], s25 offen lds
    v_mfma_f32_16x16x32_bf16 v[228:231], v[180:183], v[64:67], v[228:231]
    s_waitcnt lgkmcnt(12)
    ds_read_b64_tr_b16 v[180:181], v242 offset:32768
    v_mfma_f32_16x16x32_bf16 v[216:219], v[184:187], v[60:63], v[216:219]
    ds_read_b64_tr_b16 v[182:183], v242 offset:33792
    v_mfma_f32_16x16x32_bf16 v[232:235], v[184:187], v[64:67], v[232:235]
    s_waitcnt lgkmcnt(12)
    s_waitcnt vmcnt(14)
    ds_read_b64_tr_b16 v[184:185], v243 offset:32768
    v_mfma_f32_16x16x32_bf16 v[204:207], v[188:191], v[68:71], v[204:207]
    ds_read_b64_tr_b16 v[186:187], v243 offset:33792
    buffer_load_dwordx4 v[108:111], v244, s[16:19], s71 offen offset:0 sc1
    v_mfma_f32_16x16x32_bf16 v[220:223], v[188:191], v[72:75], v[220:223]
    s_waitcnt lgkmcnt(12)
    ds_read_b64_tr_b16 v[188:189], v240 offset:36864
    v_mfma_f32_16x16x32_bf16 v[208:211], v[192:195], v[68:71], v[208:211]
    ds_read_b64_tr_b16 v[190:191], v240 offset:37888
    buffer_load_dwordx4 v[112:115], v244, s[16:19], s71 offen offset:256 sc1
    v_mfma_f32_16x16x32_bf16 v[224:227], v[192:195], v[72:75], v[224:227]
    s_waitcnt lgkmcnt(12)
    ds_read_b64_tr_b16 v[192:193], v241 offset:36864
    v_mfma_f32_16x16x32_bf16 v[212:215], v[196:199], v[68:71], v[212:215]
    ds_read_b64_tr_b16 v[194:195], v241 offset:37888
    v_mfma_f32_16x16x32_bf16 v[228:231], v[196:199], v[72:75], v[228:231]
    s_waitcnt lgkmcnt(12)
    ds_read_b64_tr_b16 v[196:197], v242 offset:36864
    v_mfma_f32_16x16x32_bf16 v[216:219], v[200:203], v[68:71], v[216:219]
    ds_read_b64_tr_b16 v[198:199], v242 offset:37888
    v_mfma_f32_16x16x32_bf16 v[232:235], v[200:203], v[72:75], v[232:235]
    s_waitcnt lgkmcnt(12)
    s_waitcnt vmcnt(12)
    ds_read_b64_tr_b16 v[200:201], v243 offset:36864
    v_mfma_f32_16x16x32_bf16 v[204:207], v[172:175], v[76:79], v[204:207]
    ds_read_b64_tr_b16 v[202:203], v243 offset:37888
    buffer_load_dwordx4 v[116:119], v244, s[16:19], s71 offen offset:2048 sc1
    v_mfma_f32_16x16x32_bf16 v[220:223], v[172:175], v[80:83], v[220:223]
    s_waitcnt lgkmcnt(12)
    ds_read_b64_tr_b16 v[172:173], v240 offset:40960
    v_mfma_f32_16x16x32_bf16 v[208:211], v[176:179], v[76:79], v[208:211]
    ds_read_b64_tr_b16 v[174:175], v240 offset:41984
    buffer_load_dwordx4 v[120:123], v244, s[16:19], s71 offen offset:2304 sc1
    s_add_u32 s78, s78, 4096
    s_and_b32 s78, s78, 0xffff
    s_add_u32 s71, s77, s78
    v_mfma_f32_16x16x32_bf16 v[224:227], v[176:179], v[80:83], v[224:227]
    s_waitcnt lgkmcnt(12)
    ds_read_b64_tr_b16 v[176:177], v241 offset:40960
    v_mfma_f32_16x16x32_bf16 v[212:215], v[180:183], v[76:79], v[212:215]
    ds_read_b64_tr_b16 v[178:179], v241 offset:41984
    s_add_u32 m0, s80, 122880
    s_add_u32 s25, s76, 1572864
    s_and_b32 s25, s25, 2097151
    buffer_load_dwordx4 v236, s[4:7], s25 offen lds
    s_add_u32 m0, s80, 126976
    s_add_u32 s25, s76, 1638400
    s_and_b32 s25, s25, 2097151
    buffer_load_dwordx4 v236, s[4:7], s25 offen lds
    v_mfma_f32_16x16x32_bf16 v[228:231], v[180:183], v[80:83], v[228:231]
    s_waitcnt lgkmcnt(12)
    ds_read_b64_tr_b16 v[180:181], v242 offset:40960
    v_mfma_f32_16x16x32_bf16 v[216:219], v[184:187], v[76:79], v[216:219]
    ds_read_b64_tr_b16 v[182:183], v242 offset:41984
    v_mfma_f32_16x16x32_bf16 v[232:235], v[184:187], v[80:83], v[232:235]
    s_waitcnt lgkmcnt(12)
    s_waitcnt vmcnt(14)
    ds_read_b64_tr_b16 v[184:185], v243 offset:40960
    v_mfma_f32_16x16x32_bf16 v[204:207], v[188:191], v[84:87], v[204:207]
    ds_read_b64_tr_b16 v[186:187], v243 offset:41984
    buffer_load_dwordx4 v[124:127], v244, s[16:19], s71 offen offset:0 sc1
    v_mfma_f32_16x16x32_bf16 v[220:223], v[188:191], v[88:91], v[220:223]
    s_waitcnt lgkmcnt(12)
    ds_read_b64_tr_b16 v[188:189], v240 offset:45056
    v_mfma_f32_16x16x32_bf16 v[208:211], v[192:195], v[84:87], v[208:211]
    ds_read_b64_tr_b16 v[190:191], v240 offset:46080
    buffer_load_dwordx4 v[128:131], v244, s[16:19], s71 offen offset:256 sc1
    v_mfma_f32_16x16x32_bf16 v[224:227], v[192:195], v[88:91], v[224:227]
    s_waitcnt lgkmcnt(12)
    ds_read_b64_tr_b16 v[192:193], v241 offset:45056
    v_mfma_f32_16x16x32_bf16 v[212:215], v[196:199], v[84:87], v[212:215]
    ds_read_b64_tr_b16 v[194:195], v241 offset:46080
    v_mfma_f32_16x16x32_bf16 v[228:231], v[196:199], v[88:91], v[228:231]
    s_waitcnt lgkmcnt(12)
    ds_read_b64_tr_b16 v[196:197], v242 offset:45056
    v_mfma_f32_16x16x32_bf16 v[216:219], v[200:203], v[84:87], v[216:219]
    ds_read_b64_tr_b16 v[198:199], v242 offset:46080
    v_mfma_f32_16x16x32_bf16 v[232:235], v[200:203], v[88:91], v[232:235]
    s_waitcnt lgkmcnt(12)
    s_waitcnt vmcnt(12)
    ds_read_b64_tr_b16 v[200:201], v243 offset:45056
    v_mfma_f32_16x16x32_bf16 v[204:207], v[172:175], v[92:95], v[204:207]
    ds_read_b64_tr_b16 v[202:203], v243 offset:46080
    buffer_load_dwordx4 v[132:135], v244, s[16:19], s71 offen offset:2048 sc1
    v_mfma_f32_16x16x32_bf16 v[220:223], v[172:175], v[96:99], v[220:223]
    s_waitcnt lgkmcnt(12)
    ds_read_b64_tr_b16 v[172:173], v240 offset:49152
    v_mfma_f32_16x16x32_bf16 v[208:211], v[176:179], v[92:95], v[208:211]
    ds_read_b64_tr_b16 v[174:175], v240 offset:50176
    buffer_load_dwordx4 v[136:139], v244, s[16:19], s71 offen offset:2304 sc1
    s_add_u32 s78, s78, 4096
    s_and_b32 s78, s78, 0xffff
    s_add_u32 s71, s77, s78
    v_mfma_f32_16x16x32_bf16 v[224:227], v[176:179], v[96:99], v[224:227]
    s_waitcnt lgkmcnt(12)
    ds_read_b64_tr_b16 v[176:177], v241 offset:49152
    v_mfma_f32_16x16x32_bf16 v[212:215], v[180:183], v[92:95], v[212:215]
    ds_read_b64_tr_b16 v[178:179], v241 offset:50176
    v_mfma_f32_16x16x32_bf16 v[228:231], v[180:183], v[96:99], v[228:231]
    s_waitcnt lgkmcnt(12)
    ds_read_b64_tr_b16 v[180:181], v242 offset:49152
    v_mfma_f32_16x16x32_bf16 v[216:219], v[184:187], v[92:95], v[216:219]
    ds_read_b64_tr_b16 v[182:183], v242 offset:50176
    v_mfma_f32_16x16x32_bf16 v[232:235], v[184:187], v[96:99], v[232:235]
    s_waitcnt lgkmcnt(12)
    s_waitcnt vmcnt(12)
    ds_read_b64_tr_b16 v[184:185], v243 offset:49152
    v_mfma_f32_16x16x32_bf16 v[204:207], v[188:191], v[100:103], v[204:207]
    ds_read_b64_tr_b16 v[186:187], v243 offset:50176
    buffer_load_dwordx4 v[140:143], v244, s[16:19], s71 offen offset:0 sc1
    v_mfma_f32_16x16x32_bf16 v[220:223], v[188:191], v[104:107], v[220:223]
    s_waitcnt lgkmcnt(12)
    ds_read_b64_tr_b16 v[188:189], v240 offset:53248
    v_mfma_f32_16x16x32_bf16 v[208:211], v[192:195], v[100:103], v[208:211]
    ds_read_b64_tr_b16 v[190:191], v240 offset:54272
    buffer_load_dwordx4 v[144:147], v244, s[16:19], s71 offen offset:256 sc1
    v_mfma_f32_16x16x32_bf16 v[224:227], v[192:195], v[104:107], v[224:227]
    s_waitcnt lgkmcnt(12)
    ds_read_b64_tr_b16 v[192:193], v241 offset:53248
    v_mfma_f32_16x16x32_bf16 v[212:215], v[196:199], v[100:103], v[212:215]
    ds_read_b64_tr_b16 v[194:195], v241 offset:54272
    v_mfma_f32_16x16x32_bf16 v[228:231], v[196:199], v[104:107], v[228:231]
    s_waitcnt lgkmcnt(12)
    ds_read_b64_tr_b16 v[196:197], v242 offset:53248
    v_mfma_f32_16x16x32_bf16 v[216:219], v[200:203], v[100:103], v[216:219]
    ds_read_b64_tr_b16 v[198:199], v242 offset:54272
    v_mfma_f32_16x16x32_bf16 v[232:235], v[200:203], v[104:107], v[232:235]
    s_waitcnt lgkmcnt(12)
    s_waitcnt vmcnt(10)
    ds_read_b64_tr_b16 v[200:201], v243 offset:53248
    v_mfma_f32_16x16x32_bf16 v[204:207], v[172:175], v[108:111], v[204:207]
    ds_read_b64_tr_b16 v[202:203], v243 offset:54272
    buffer_load_dwordx4 v[148:151], v244, s[16:19], s71 offen offset:2048 sc1
    v_mfma_f32_16x16x32_bf16 v[220:223], v[172:175], v[112:115], v[220:223]
    s_waitcnt lgkmcnt(12)
    ds_read_b64_tr_b16 v[172:173], v240 offset:57344
    v_mfma_f32_16x16x32_bf16 v[208:211], v[176:179], v[108:111], v[208:211]
    ds_read_b64_tr_b16 v[174:175], v240 offset:58368
    buffer_load_dwordx4 v[152:155], v244, s[16:19], s71 offen offset:2304 sc1
    s_add_u32 s78, s78, 4096
    s_and_b32 s78, s78, 0xffff
    s_add_u32 s71, s77, s78
    v_mfma_f32_16x16x32_bf16 v[224:227], v[176:179], v[112:115], v[224:227]
    s_waitcnt lgkmcnt(12)
    ds_read_b64_tr_b16 v[176:177], v241 offset:57344
    v_mfma_f32_16x16x32_bf16 v[212:215], v[180:183], v[108:111], v[212:215]
    ds_read_b64_tr_b16 v[178:179], v241 offset:58368
    v_mfma_f32_16x16x32_bf16 v[228:231], v[180:183], v[112:115], v[228:231]
    s_waitcnt lgkmcnt(12)
    ds_read_b64_tr_b16 v[180:181], v242 offset:57344
    v_mfma_f32_16x16x32_bf16 v[216:219], v[184:187], v[108:111], v[216:219]
    ds_read_b64_tr_b16 v[182:183], v242 offset:58368
    v_mfma_f32_16x16x32_bf16 v[232:235], v[184:187], v[112:115], v[232:235]
    s_waitcnt lgkmcnt(12)
    s_waitcnt vmcnt(10)
    ds_read_b64_tr_b16 v[184:185], v243 offset:57344
    v_mfma_f32_16x16x32_bf16 v[204:207], v[188:191], v[116:119], v[204:207]
    ds_read_b64_tr_b16 v[186:187], v243 offset:58368
    buffer_load_dwordx4 v[156:159], v244, s[16:19], s71 offen offset:0 sc1
    v_mfma_f32_16x16x32_bf16 v[220:223], v[188:191], v[120:123], v[220:223]
    s_waitcnt lgkmcnt(12)
    ds_read_b64_tr_b16 v[188:189], v240 offset:61440
    v_mfma_f32_16x16x32_bf16 v[208:211], v[192:195], v[116:119], v[208:211]
    ds_read_b64_tr_b16 v[190:191], v240 offset:62464
    buffer_load_dwordx4 v[160:163], v244, s[16:19], s71 offen offset:256 sc1
    v_mfma_f32_16x16x32_bf16 v[224:227], v[192:195], v[120:123], v[224:227]
    s_waitcnt lgkmcnt(12)
    ds_read_b64_tr_b16 v[192:193], v241 offset:61440
    v_mfma_f32_16x16x32_bf16 v[212:215], v[196:199], v[116:119], v[212:215]
    ds_read_b64_tr_b16 v[194:195], v241 offset:62464
    v_mfma_f32_16x16x32_bf16 v[228:231], v[196:199], v[120:123], v[228:231]
    s_waitcnt lgkmcnt(12)
    ds_read_b64_tr_b16 v[196:197], v242 offset:61440
    v_mfma_f32_16x16x32_bf16 v[216:219], v[200:203], v[116:119], v[216:219]
    ds_read_b64_tr_b16 v[198:199], v242 offset:62464
    v_mfma_f32_16x16x32_bf16 v[232:235], v[200:203], v[120:123], v[232:235]
    s_waitcnt lgkmcnt(12)
    s_waitcnt vmcnt(8)
    ds_read_b64_tr_b16 v[200:201], v243 offset:61440
    v_mfma_f32_16x16x32_bf16 v[204:207], v[172:175], v[124:127], v[204:207]
    ds_read_b64_tr_b16 v[202:203], v243 offset:62464
    buffer_load_dwordx4 v[164:167], v244, s[16:19], s71 offen offset:2048 sc1
    v_mfma_f32_16x16x32_bf16 v[220:223], v[172:175], v[128:131], v[220:223]
    v_add_u32 v240, s73, v240
    v_add_u32 v241, s73, v241
    v_add_u32 v242, s73, v242
    v_add_u32 v243, s73, v243
    s_waitcnt lgkmcnt(0)
    s_barrier
    ds_read_b64_tr_b16 v[172:173], v240 offset:0
    v_mfma_f32_16x16x32_bf16 v[208:211], v[176:179], v[124:127], v[208:211]
    ds_read_b64_tr_b16 v[174:175], v240 offset:1024
    buffer_load_dwordx4 v[168:171], v244, s[16:19], s71 offen offset:2304 sc1
    s_add_u32 s78, s78, 4096
    s_and_b32 s78, s78, 0xffff
    s_add_u32 s71, s77, s78
    v_mfma_f32_16x16x32_bf16 v[224:227], v[176:179], v[128:131], v[224:227]
    ds_read_b64_tr_b16 v[176:177], v241 offset:0
    v_mfma_f32_16x16x32_bf16 v[212:215], v[180:183], v[124:127], v[212:215]
    ds_read_b64_tr_b16 v[178:179], v241 offset:1024
    v_mfma_f32_16x16x32_bf16 v[228:231], v[180:183], v[128:131], v[228:231]
    ds_read_b64_tr_b16 v[180:181], v242 offset:0
    v_mfma_f32_16x16x32_bf16 v[216:219], v[184:187], v[124:127], v[216:219]
    ds_read_b64_tr_b16 v[182:183], v242 offset:1024
    v_mfma_f32_16x16x32_bf16 v[232:235], v[184:187], v[128:131], v[232:235]
    s_waitcnt vmcnt(8)
    ds_read_b64_tr_b16 v[184:185], v243 offset:0
    v_mfma_f32_16x16x32_bf16 v[204:207], v[188:191], v[132:135], v[204:207]
    ds_read_b64_tr_b16 v[186:187], v243 offset:1024
    buffer_load_dwordx4 v[12:15], v244, s[16:19], s71 offen offset:0 sc1
    v_mfma_f32_16x16x32_bf16 v[220:223], v[188:191], v[136:139], v[220:223]
    ds_read_b64_tr_b16 v[188:189], v240 offset:4096
    v_mfma_f32_16x16x32_bf16 v[208:211], v[192:195], v[132:135], v[208:211]
    ds_read_b64_tr_b16 v[190:191], v240 offset:5120
    buffer_load_dwordx4 v[16:19], v244, s[16:19], s71 offen offset:256 sc1
    v_mfma_f32_16x16x32_bf16 v[224:227], v[192:195], v[136:139], v[224:227]
    ds_read_b64_tr_b16 v[192:193], v241 offset:4096
    v_mfma_f32_16x16x32_bf16 v[212:215], v[196:199], v[132:135], v[212:215]
    ds_read_b64_tr_b16 v[194:195], v241 offset:5120
    v_mfma_f32_16x16x32_bf16 v[228:231], v[196:199], v[136:139], v[228:231]
    ds_read_b64_tr_b16 v[196:197], v242 offset:4096
    v_mfma_f32_16x16x32_bf16 v[216:219], v[200:203], v[132:135], v[216:219]
    ds_read_b64_tr_b16 v[198:199], v242 offset:5120
    v_mfma_f32_16x16x32_bf16 v[232:235], v[200:203], v[136:139], v[232:235]
    s_waitcnt lgkmcnt(12)
    s_waitcnt vmcnt(8)
    ds_read_b64_tr_b16 v[200:201], v243 offset:4096
    v_mfma_f32_16x16x32_bf16 v[204:207], v[172:175], v[140:143], v[204:207]
    ds_read_b64_tr_b16 v[202:203], v243 offset:5120
    buffer_load_dwordx4 v[20:23], v244, s[16:19], s71 offen offset:2048 sc1
    v_mfma_f32_16x16x32_bf16 v[220:223], v[172:175], v[144:147], v[220:223]
    s_waitcnt lgkmcnt(12)
    ds_read_b64_tr_b16 v[172:173], v240 offset:8192
    v_mfma_f32_16x16x32_bf16 v[208:211], v[176:179], v[140:143], v[208:211]
    ds_read_b64_tr_b16 v[174:175], v240 offset:9216
    buffer_load_dwordx4 v[24:27], v244, s[16:19], s71 offen offset:2304 sc1
    s_add_u32 s78, s78, 4096
    s_and_b32 s78, s78, 0xffff
    s_add_u32 s71, s77, s78
    v_mfma_f32_16x16x32_bf16 v[224:227], v[176:179], v[144:147], v[224:227]
    s_waitcnt lgkmcnt(12)
    ds_read_b64_tr_b16 v[176:177], v241 offset:8192
    v_mfma_f32_16x16x32_bf16 v[212:215], v[180:183], v[140:143], v[212:215]
    ds_read_b64_tr_b16 v[178:179], v241 offset:9216
    v_mfma_f32_16x16x32_bf16 v[228:231], v[180:183], v[144:147], v[228:231]
    s_waitcnt lgkmcnt(12)
    ds_read_b64_tr_b16 v[180:181], v242 offset:8192
    v_mfma_f32_16x16x32_bf16 v[216:219], v[184:187], v[140:143], v[216:219]
    ds_read_b64_tr_b16 v[182:183], v242 offset:9216
    v_mfma_f32_16x16x32_bf16 v[232:235], v[184:187], v[144:147], v[232:235]
    s_waitcnt lgkmcnt(12)
    s_waitcnt vmcnt(8)
    ds_read_b64_tr_b16 v[184:185], v243 offset:8192
    v_mfma_f32_16x16x32_bf16 v[204:207], v[188:191], v[148:151], v[204:207]
    ds_read_b64_tr_b16 v[186:187], v243 offset:9216
    buffer_load_dwordx4 v[28:31], v244, s[16:19], s71 offen offset:0 sc1
    v_mfma_f32_16x16x32_bf16 v[220:223], v[188:191], v[152:155], v[220:223]
    s_waitcnt lgkmcnt(12)
    ds_read_b64_tr_b16 v[188:189], v240 offset:12288
    v_mfma_f32_16x16x32_bf16 v[208:211], v[192:195], v[148:151], v[208:211]
    ds_read_b64_tr_b16 v[190:191], v240 offset:13312
    buffer_load_dwordx4 v[32:35], v244, s[16:19], s71 offen offset:256 sc1
    v_mfma_f32_16x16x32_bf16 v[224:227], v[192:195], v[152:155], v[224:227]
    s_waitcnt lgkmcnt(12)
    ds_read_b64_tr_b16 v[192:193], v241 offset:12288
    v_mfma_f32_16x16x32_bf16 v[212:215], v[196:199], v[148:151], v[212:215]
    ds_read_b64_tr_b16 v[194:195], v241 offset:13312
    v_mfma_f32_16x16x32_bf16 v[228:231], v[196:199], v[152:155], v[228:231]
    s_waitcnt lgkmcnt(12)
    ds_read_b64_tr_b16 v[196:197], v242 offset:12288
    v_mfma_f32_16x16x32_bf16 v[216:219], v[200:203], v[148:151], v[216:219]
    ds_read_b64_tr_b16 v[198:199], v242 offset:13312
    v_mfma_f32_16x16x32_bf16 v[232:235], v[200:203], v[152:155], v[232:235]
    s_waitcnt lgkmcnt(12)
    s_waitcnt vmcnt(8)
    ds_read_b64_tr_b16 v[200:201], v243 offset:12288
    v_mfma_f32_16x16x32_bf16 v[204:207], v[172:175], v[156:159], v[204:207]
    ds_read_b64_tr_b16 v[202:203], v243 offset:13312
    buffer_load_dwordx4 v[36:39], v244, s[16:19], s71 offen offset:2048 sc1
    v_mfma_f32_16x16x32_bf16 v[220:223], v[172:175], v[160:163], v[220:223]
    s_waitcnt lgkmcnt(12)
    ds_read_b64_tr_b16 v[172:173], v240 offset:16384
    v_mfma_f32_16x16x32_bf16 v[208:211], v[176:179], v[156:159], v[208:211]
    ds_read_b64_tr_b16 v[174:175], v240 offset:17408
    buffer_load_dwordx4 v[40:43], v244, s[16:19], s71 offen offset:2304 sc1
    s_add_u32 s78, s78, 4096
    s_and_b32 s78, s78, 0xffff
    s_add_u32 s71, s77, s78
    v_mfma_f32_16x16x32_bf16 v[224:227], v[176:179], v[160:163], v[224:227]
    s_waitcnt lgkmcnt(12)
    ds_read_b64_tr_b16 v[176:177], v241 offset:16384
    v_mfma_f32_16x16x32_bf16 v[212:215], v[180:183], v[156:159], v[212:215]
    ds_read_b64_tr_b16 v[178:179], v241 offset:17408
    v_mfma_f32_16x16x32_bf16 v[228:231], v[180:183], v[160:163], v[228:231]
    s_waitcnt lgkmcnt(12)
    ds_read_b64_tr_b16 v[180:181], v242 offset:16384
    v_mfma_f32_16x16x32_bf16 v[216:219], v[184:187], v[156:159], v[216:219]
    ds_read_b64_tr_b16 v[182:183], v242 offset:17408
    v_mfma_f32_16x16x32_bf16 v[232:235], v[184:187], v[160:163], v[232:235]
    s_waitcnt lgkmcnt(12)
    s_waitcnt vmcnt(8)
    ds_read_b64_tr_b16 v[184:185], v243 offset:16384
    v_mfma_f32_16x16x32_bf16 v[204:207], v[188:191], v[164:167], v[204:207]
    ds_read_b64_tr_b16 v[186:187], v243 offset:17408
    buffer_load_dwordx4 v[44:47], v244, s[16:19], s71 offen offset:0 sc1
    v_mfma_f32_16x16x32_bf16 v[220:223], v[188:191], v[168:171], v[220:223]
    s_waitcnt lgkmcnt(12)
    ds_read_b64_tr_b16 v[188:189], v240 offset:20480
    v_mfma_f32_16x16x32_bf16 v[208:211], v[192:195], v[164:167], v[208:211]
    ds_read_b64_tr_b16 v[190:191], v240 offset:21504
    buffer_load_dwordx4 v[48:51], v244, s[16:19], s71 offen offset:256 sc1
    v_mfma_f32_16x16x32_bf16 v[224:227], v[192:195], v[168:171], v[224:227]
    s_waitcnt lgkmcnt(12)
    ds_read_b64_tr_b16 v[192:193], v241 offset:20480
    v_mfma_f32_16x16x32_bf16 v[212:215], v[196:199], v[164:167], v[212:215]
    ds_read_b64_tr_b16 v[194:195], v241 offset:21504
    v_mfma_f32_16x16x32_bf16 v[228:231], v[196:199], v[168:171], v[228:231]
    s_waitcnt lgkmcnt(12)
    ds_read_b64_tr_b16 v[196:197], v242 offset:20480
    v_mfma_f32_16x16x32_bf16 v[216:219], v[200:203], v[164:167], v[216:219]
    ds_read_b64_tr_b16 v[198:199], v242 offset:21504
    v_mfma_f32_16x16x32_bf16 v[232:235], v[200:203], v[168:171], v[232:235]
    s_waitcnt lgkmcnt(12)
    s_waitcnt vmcnt(8)
    ds_read_b64_tr_b16 v[200:201], v243 offset:20480
    v_mfma_f32_16x16x32_bf16 v[204:207], v[172:175], v[12:15], v[204:207]
    ds_read_b64_tr_b16 v[202:203], v243 offset:21504
    buffer_load_dwordx4 v[52:55], v244, s[16:19], s71 offen offset:2048 sc1
    v_mfma_f32_16x16x32_bf16 v[220:223], v[172:175], v[16:19], v[220:223]
    s_waitcnt lgkmcnt(12)
    ds_read_b64_tr_b16 v[172:173], v240 offset:24576
    v_mfma_f32_16x16x32_bf16 v[208:211], v[176:179], v[12:15], v[208:211]
    ds_read_b64_tr_b16 v[174:175], v240 offset:25600
    buffer_load_dwordx4 v[56:59], v244, s[16:19], s71 offen offset:2304 sc1
    s_add_u32 s78, s78, 4096
    s_and_b32 s78, s78, 0xffff
    s_add_u32 s71, s77, s78
    v_mfma_f32_16x16x32_bf16 v[224:227], v[176:179], v[16:19], v[224:227]
    s_waitcnt lgkmcnt(12)
    ds_read_b64_tr_b16 v[176:177], v241 offset:24576
    v_mfma_f32_16x16x32_bf16 v[212:215], v[180:183], v[12:15], v[212:215]
    ds_read_b64_tr_b16 v[178:179], v241 offset:25600
    v_mfma_f32_16x16x32_bf16 v[228:231], v[180:183], v[16:19], v[228:231]
    s_waitcnt lgkmcnt(12)
    ds_read_b64_tr_b16 v[180:181], v242 offset:24576
    v_mfma_f32_16x16x32_bf16 v[216:219], v[184:187], v[12:15], v[216:219]
    ds_read_b64_tr_b16 v[182:183], v242 offset:25600
    v_mfma_f32_16x16x32_bf16 v[232:235], v[184:187], v[16:19], v[232:235]
    s_waitcnt lgkmcnt(12)
    s_waitcnt vmcnt(8)
    ds_read_b64_tr_b16 v[184:185], v243 offset:24576
    v_mfma_f32_16x16x32_bf16 v[204:207], v[188:191], v[20:23], v[204:207]
    ds_read_b64_tr_b16 v[186:187], v243 offset:25600
    buffer_load_dwordx4 v[60:63], v244, s[16:19], s71 offen offset:0 sc1
    v_mfma_f32_16x16x32_bf16 v[220:223], v[188:191], v[24:27], v[220:223]
    s_waitcnt lgkmcnt(12)
    ds_read_b64_tr_b16 v[188:189], v240 offset:28672
    v_mfma_f32_16x16x32_bf16 v[208:211], v[192:195], v[20:23], v[208:211]
    ds_read_b64_tr_b16 v[190:191], v240 offset:29696
    buffer_load_dwordx4 v[64:67], v244, s[16:19], s71 offen offset:256 sc1
    v_mfma_f32_16x16x32_bf16 v[224:227], v[192:195], v[24:27], v[224:227]
    s_waitcnt lgkmcnt(12)
    ds_read_b64_tr_b16 v[192:193], v241 offset:28672
    v_mfma_f32_16x16x32_bf16 v[212:215], v[196:199], v[20:23], v[212:215]
    ds_read_b64_tr_b16 v[194:195], v241 offset:29696
    v_mfma_f32_16x16x32_bf16 v[228:231], v[196:199], v[24:27], v[228:231]
    s_waitcnt lgkmcnt(12)
    ds_read_b64_tr_b16 v[196:197], v242 offset:28672
    v_mfma_f32_16x16x32_bf16 v[216:219], v[200:203], v[20:23], v[216:219]
    ds_read_b64_tr_b16 v[198:199], v242 offset:29696
    v_mfma_f32_16x16x32_bf16 v[232:235], v[200:203], v[24:27], v[232:235]
    s_waitcnt lgkmcnt(12)
    s_waitcnt vmcnt(8)
    ds_read_b64_tr_b16 v[200:201], v243 offset:28672
    v_mfma_f32_16x16x32_bf16 v[204:207], v[172:175], v[28:31], v[204:207]
    ds_read_b64_tr_b16 v[202:203], v243 offset:29696
    buffer_load_dwordx4 v[68:71], v244, s[16:19], s71 offen offset:2048 sc1
    v_mfma_f32_16x16x32_bf16 v[220:223], v[172:175], v[32:35], v[220:223]
    s_waitcnt lgkmcnt(12)
    ds_read_b64_tr_b16 v[172:173], v240 offset:32768
    v_mfma_f32_16x16x32_bf16 v[208:211], v[176:179], v[28:31], v[208:211]
    ds_read_b64_tr_b16 v[174:175], v240 offset:33792
    buffer_load_dwordx4 v[72:75], v244, s[16:19], s71 offen offset:2304 sc1
    s_add_u32 s78, s78, 4096
    s_and_b32 s78, s78, 0xffff
    s_add_u32 s71, s77, s78
    v_mfma_f32_16x16x32_bf16 v[224:227], v[176:179], v[32:35], v[224:227]
    s_waitcnt lgkmcnt(12)
    ds_read_b64_tr_b16 v[176:177], v241 offset:32768
    v_mfma_f32_16x16x32_bf16 v[212:215], v[180:183], v[28:31], v[212:215]
    ds_read_b64_tr_b16 v[178:179], v241 offset:33792
    v_mfma_f32_16x16x32_bf16 v[228:231], v[180:183], v[32:35], v[228:231]
    s_waitcnt lgkmcnt(12)
    ds_read_b64_tr_b16 v[180:181], v242 offset:32768
    v_mfma_f32_16x16x32_bf16 v[216:219], v[184:187], v[28:31], v[216:219]
    ds_read_b64_tr_b16 v[182:183], v242 offset:33792
    v_mfma_f32_16x16x32_bf16 v[232:235], v[184:187], v[32:35], v[232:235]
    s_waitcnt lgkmcnt(12)
    s_waitcnt vmcnt(8)
    ds_read_b64_tr_b16 v[184:185], v243 offset:32768
    v_mfma_f32_16x16x32_bf16 v[204:207], v[188:191], v[36:39], v[204:207]
    ds_read_b64_tr_b16 v[186:187], v243 offset:33792
    buffer_load_dwordx4 v[76:79], v244, s[16:19], s71 offen offset:0 sc1
    v_mfma_f32_16x16x32_bf16 v[220:223], v[188:191], v[40:43], v[220:223]
    s_waitcnt lgkmcnt(12)
    ds_read_b64_tr_b16 v[188:189], v240 offset:36864
    v_mfma_f32_16x16x32_bf16 v[208:211], v[192:195], v[36:39], v[208:211]
    ds_read_b64_tr_b16 v[190:191], v240 offset:37888
    buffer_load_dwordx4 v[80:83], v244, s[16:19], s71 offen offset:256 sc1
    v_mfma_f32_16x16x32_bf16 v[224:227], v[192:195], v[40:43], v[224:227]
    s_waitcnt lgkmcnt(12)
    ds_read_b64_tr_b16 v[192:193], v241 offset:36864
    v_mfma_f32_16x16x32_bf16 v[212:215], v[196:199], v[36:39], v[212:215]
    ds_read_b64_tr_b16 v[194:195], v241 offset:37888
    v_mfma_f32_16x16x32_bf16 v[228:231], v[196:199], v[40:43], v[228:231]
    s_waitcnt lgkmcnt(12)
    ds_read_b64_tr_b16 v[196:197], v242 offset:36864
    v_mfma_f32_16x16x32_bf16 v[216:219], v[200:203], v[36:39], v[216:219]
    ds_read_b64_tr_b16 v[198:199], v242 offset:37888
    v_mfma_f32_16x16x32_bf16 v[232:235], v[200:203], v[40:43], v[232:235]
    s_waitcnt lgkmcnt(12)
    s_waitcnt vmcnt(8)
    ds_read_b64_tr_b16 v[200:201], v243 offset:36864
    v_mfma_f32_16x16x32_bf16 v[204:207], v[172:175], v[44:47], v[204:207]
    ds_read_b64_tr_b16 v[202:203], v243 offset:37888
    buffer_load_dwordx4 v[84:87], v244, s[16:19], s71 offen offset:2048 sc1
    v_mfma_f32_16x16x32_bf16 v[220:223], v[172:175], v[48:51], v[220:223]
    s_waitcnt lgkmcnt(12)
    ds_read_b64_tr_b16 v[172:173], v240 offset:40960
    v_mfma_f32_16x16x32_bf16 v[208:211], v[176:179], v[44:47], v[208:211]
    ds_read_b64_tr_b16 v[174:175], v240 offset:41984
    buffer_load_dwordx4 v[88:91], v244, s[16:19], s71 offen offset:2304 sc1
    s_add_u32 s78, s78, 4096
    s_and_b32 s78, s78, 0xffff
    s_add_u32 s71, s77, s78
    v_mfma_f32_16x16x32_bf16 v[224:227], v[176:179], v[48:51], v[224:227]
    s_waitcnt lgkmcnt(12)
    ds_read_b64_tr_b16 v[176:177], v241 offset:40960
    v_mfma_f32_16x16x32_bf16 v[212:215], v[180:183], v[44:47], v[212:215]
    ds_read_b64_tr_b16 v[178:179], v241 offset:41984
    v_mfma_f32_16x16x32_bf16 v[228:231], v[180:183], v[48:51], v[228:231]
    s_waitcnt lgkmcnt(12)
    ds_read_b64_tr_b16 v[180:181], v242 offset:40960
    v_mfma_f32_16x16x32_bf16 v[216:219], v[184:187], v[44:47], v[216:219]
    ds_read_b64_tr_b16 v[182:183], v242 offset:41984
    v_mfma_f32_16x16x32_bf16 v[232:235], v[184:187], v[48:51], v[232:235]
    s_waitcnt lgkmcnt(12)
    s_waitcnt vmcnt(8)
    ds_read_b64_tr_b16 v[184:185], v243 offset:40960
    v_mfma_f32_16x16x32_bf16 v[204:207], v[188:191], v[52:55], v[204:207]
    ds_read_b64_tr_b16 v[186:187], v243 offset:41984
    buffer_load_dwordx4 v[92:95], v244, s[16:19], s71 offen offset:0 sc1
    v_mfma_f32_16x16x32_bf16 v[220:223], v[188:191], v[56:59], v[220:223]
    s_waitcnt lgkmcnt(12)
    ds_read_b64_tr_b16 v[188:189], v240 offset:45056
    v_mfma_f32_16x16x32_bf16 v[208:211], v[192:195], v[52:55], v[208:211]
    ds_read_b64_tr_b16 v[190:191], v240 offset:46080
    buffer_load_dwordx4 v[96:99], v244, s[16:19], s71 offen offset:256 sc1
    v_mfma_f32_16x16x32_bf16 v[224:227], v[192:195], v[56:59], v[224:227]
    s_waitcnt lgkmcnt(12)
    ds_read_b64_tr_b16 v[192:193], v241 offset:45056
    v_mfma_f32_16x16x32_bf16 v[212:215], v[196:199], v[52:55], v[212:215]
    ds_read_b64_tr_b16 v[194:195], v241 offset:46080
    v_mfma_f32_16x16x32_bf16 v[228:231], v[196:199], v[56:59], v[228:231]
    s_waitcnt lgkmcnt(12)
    ds_read_b64_tr_b16 v[196:197], v242 offset:45056
    v_mfma_f32_16x16x32_bf16 v[216:219], v[200:203], v[52:55], v[216:219]
    ds_read_b64_tr_b16 v[198:199], v242 offset:46080
    v_mfma_f32_16x16x32_bf16 v[232:235], v[200:203], v[56:59], v[232:235]
    s_waitcnt lgkmcnt(12)
    s_waitcnt vmcnt(8)
    ds_read_b64_tr_b16 v[200:201], v243 offset:45056
    v_mfma_f32_16x16x32_bf16 v[204:207], v[172:175], v[60:63], v[204:207]
    ds_read_b64_tr_b16 v[202:203], v243 offset:46080
    buffer_load_dwordx4 v[100:103], v244, s[16:19], s71 offen offset:2048 sc1
    v_mfma_f32_16x16x32_bf16 v[220:223], v[172:175], v[64:67], v[220:223]
    s_waitcnt lgkmcnt(12)
    ds_read_b64_tr_b16 v[172:173], v240 offset:49152
    v_mfma_f32_16x16x32_bf16 v[208:211], v[176:179], v[60:63], v[208:211]
    ds_read_b64_tr_b16 v[174:175], v240 offset:50176
    buffer_load_dwordx4 v[104:107], v244, s[16:19], s71 offen offset:2304 sc1
    s_add_u32 s78, s78, 4096
    s_and_b32 s78, s78, 0xffff
    s_add_u32 s71, s77, s78
    v_mfma_f32_16x16x32_bf16 v[224:227], v[176:179], v[64:67], v[224:227]
    s_waitcnt lgkmcnt(12)
    ds_read_b64_tr_b16 v[176:177], v241 offset:49152
    v_mfma_f32_16x16x32_bf16 v[212:215], v[180:183], v[60:63], v[212:215]
    s_barrier
    ds_read_b64_tr_b16 v[178:179], v241 offset:50176
    v_mfma_f32_16x16x32_bf16 v[228:231], v[180:183], v[64:67], v[228:231]
    s_waitcnt lgkmcnt(12)
    ds_read_b64_tr_b16 v[180:181], v242 offset:49152
    v_mfma_f32_16x16x32_bf16 v[216:219], v[184:187], v[60:63], v[216:219]
    ds_read_b64_tr_b16 v[182:183], v242 offset:50176
    v_mfma_f32_16x16x32_bf16 v[232:235], v[184:187], v[64:67], v[232:235]
    s_waitcnt lgkmcnt(12)
    s_waitcnt vmcnt(8)
    ds_read_b64_tr_b16 v[184:185], v243 offset:49152
    v_mfma_f32_16x16x32_bf16 v[204:207], v[188:191], v[68:71], v[204:207]
    ds_read_b64_tr_b16 v[186:187], v243 offset:50176
    v_mfma_f32_16x16x32_bf16 v[220:223], v[188:191], v[72:75], v[220:223]
    s_waitcnt lgkmcnt(12)
    ds_read_b64_tr_b16 v[188:189], v240 offset:53248
    v_mfma_f32_16x16x32_bf16 v[208:211], v[192:195], v[68:71], v[208:211]
    ds_read_b64_tr_b16 v[190:191], v240 offset:54272
    v_mfma_f32_16x16x32_bf16 v[224:227], v[192:195], v[72:75], v[224:227]
    s_waitcnt lgkmcnt(12)
    ds_read_b64_tr_b16 v[192:193], v241 offset:53248
    v_mfma_f32_16x16x32_bf16 v[212:215], v[196:199], v[68:71], v[212:215]
    ds_read_b64_tr_b16 v[194:195], v241 offset:54272
    v_mfma_f32_16x16x32_bf16 v[228:231], v[196:199], v[72:75], v[228:231]
    s_waitcnt lgkmcnt(12)
    ds_read_b64_tr_b16 v[196:197], v242 offset:53248
    v_mfma_f32_16x16x32_bf16 v[216:219], v[200:203], v[68:71], v[216:219]
    ds_read_b64_tr_b16 v[198:199], v242 offset:54272
    v_mfma_f32_16x16x32_bf16 v[232:235], v[200:203], v[72:75], v[232:235]
    s_waitcnt lgkmcnt(12)
    s_waitcnt vmcnt(6)
    ds_read_b64_tr_b16 v[200:201], v243 offset:53248
    v_mfma_f32_16x16x32_bf16 v[204:207], v[172:175], v[76:79], v[204:207]
    ds_read_b64_tr_b16 v[202:203], v243 offset:54272
    v_mfma_f32_16x16x32_bf16 v[220:223], v[172:175], v[80:83], v[220:223]
    s_waitcnt lgkmcnt(12)
    ds_read_b64_tr_b16 v[172:173], v240 offset:57344
    v_mfma_f32_16x16x32_bf16 v[208:211], v[176:179], v[76:79], v[208:211]
    ds_read_b64_tr_b16 v[174:175], v240 offset:58368
    v_mfma_f32_16x16x32_bf16 v[224:227], v[176:179], v[80:83], v[224:227]
    s_waitcnt lgkmcnt(12)
    ds_read_b64_tr_b16 v[176:177], v241 offset:57344
    v_mfma_f32_16x16x32_bf16 v[212:215], v[180:183], v[76:79], v[212:215]
    ds_read_b64_tr_b16 v[178:179], v241 offset:58368
    v_mfma_f32_16x16x32_bf16 v[228:231], v[180:183], v[80:83], v[228:231]
    s_waitcnt lgkmcnt(12)
    ds_read_b64_tr_b16 v[180:181], v242 offset:57344
    v_mfma_f32_16x16x32_bf16 v[216:219], v[184:187], v[76:79], v[216:219]
    ds_read_b64_tr_b16 v[182:183], v242 offset:58368
    v_mfma_f32_16x16x32_bf16 v[232:235], v[184:187], v[80:83], v[232:235]
    s_waitcnt lgkmcnt(12)
    s_waitcnt vmcnt(4)
    ds_read_b64_tr_b16 v[184:185], v243 offset:57344
    v_mfma_f32_16x16x32_bf16 v[204:207], v[188:191], v[84:87], v[204:207]
    ds_read_b64_tr_b16 v[186:187], v243 offset:58368
    v_mfma_f32_16x16x32_bf16 v[220:223], v[188:191], v[88:91], v[220:223]
    s_waitcnt lgkmcnt(12)
    ds_read_b64_tr_b16 v[188:189], v240 offset:61440
    v_mfma_f32_16x16x32_bf16 v[208:211], v[192:195], v[84:87], v[208:211]
    ds_read_b64_tr_b16 v[190:191], v240 offset:62464
    v_mfma_f32_16x16x32_bf16 v[224:227], v[192:195], v[88:91], v[224:227]
    s_waitcnt lgkmcnt(12)
    ds_read_b64_tr_b16 v[192:193], v241 offset:61440
    v_mfma_f32_16x16x32_bf16 v[212:215], v[196:199], v[84:87], v[212:215]
    ds_read_b64_tr_b16 v[194:195], v241 offset:62464
    v_mfma_f32_16x16x32_bf16 v[228:231], v[196:199], v[88:91], v[228:231]
    s_waitcnt lgkmcnt(12)
    ds_read_b64_tr_b16 v[196:197], v242 offset:61440
    v_mfma_f32_16x16x32_bf16 v[216:219], v[200:203], v[84:87], v[216:219]
    ds_read_b64_tr_b16 v[198:199], v242 offset:62464
    v_mfma_f32_16x16x32_bf16 v[232:235], v[200:203], v[88:91], v[232:235]
    s_waitcnt lgkmcnt(12)
    s_waitcnt vmcnt(2)
    ds_read_b64_tr_b16 v[200:201], v243 offset:61440
    v_mfma_f32_16x16x32_bf16 v[204:207], v[172:175], v[92:95], v[204:207]
    ds_read_b64_tr_b16 v[202:203], v243 offset:62464
    v_mfma_f32_16x16x32_bf16 v[220:223], v[172:175], v[96:99], v[220:223]
    s_waitcnt lgkmcnt(12)
    v_mfma_f32_16x16x32_bf16 v[208:211], v[176:179], v[92:95], v[208:211]
    v_mfma_f32_16x16x32_bf16 v[224:227], v[176:179], v[96:99], v[224:227]
    s_waitcnt lgkmcnt(10)
    v_mfma_f32_16x16x32_bf16 v[212:215], v[180:183], v[92:95], v[212:215]
    v_mfma_f32_16x16x32_bf16 v[228:231], v[180:183], v[96:99], v[228:231]
    s_waitcnt lgkmcnt(8)
    v_mfma_f32_16x16x32_bf16 v[216:219], v[184:187], v[92:95], v[216:219]
    v_mfma_f32_16x16x32_bf16 v[232:235], v[184:187], v[96:99], v[232:235]
    s_waitcnt lgkmcnt(6)
    s_waitcnt vmcnt(0)
    v_mfma_f32_16x16x32_bf16 v[204:207], v[188:191], v[100:103], v[204:207]
    v_mfma_f32_16x16x32_bf16 v[220:223], v[188:191], v[104:107], v[220:223]
    s_waitcnt lgkmcnt(4)
    v_mfma_f32_16x16x32_bf16 v[208:211], v[192:195], v[100:103], v[208:211]
    v_mfma_f32_16x16x32_bf16 v[224:227], v[192:195], v[104:107], v[224:227]
    s_waitcnt lgkmcnt(2)
    v_mfma_f32_16x16x32_bf16 v[212:215], v[196:199], v[100:103], v[212:215]
    v_mfma_f32_16x16x32_bf16 v[228:231], v[196:199], v[104:107], v[228:231]
    s_waitcnt lgkmcnt(0)
    v_mfma_f32_16x16x32_bf16 v[216:219], v[200:203], v[100:103], v[216:219]
    v_mfma_f32_16x16x32_bf16 v[232:235], v[200:203], v[104:107], v[232:235]
K3_EPI:
    s_nop 7
    v_cvt_pk_bf16_f32 v204, v204, v205
    v_cvt_pk_bf16_f32 v205, v206, v207
    ds_write_b64 v246, v[204:205] offset:0
    v_cvt_pk_bf16_f32 v208, v208, v209
    v_cvt_pk_bf16_f32 v209, v210, v211
    ds_write_b64 v247, v[208:209] offset:0
    v_cvt_pk_bf16_f32 v212, v212, v213
    v_cvt_pk_bf16_f32 v213, v214, v215
    ds_write_b64 v248, v[212:213] offset:0
    v_cvt_pk_bf16_f32 v216, v216, v217
    v_cvt_pk_bf16_f32 v217, v218, v219
    ds_write_b64 v249, v[216:217] offset:0
    v_cvt_pk_bf16_f32 v220, v220, v221
    v_cvt_pk_bf16_f32 v221, v222, v223
    ds_write_b64 v246, v[220:221] offset:2048
    v_cvt_pk_bf16_f32 v224, v224, v225
    v_cvt_pk_bf16_f32 v225, v226, v227
    ds_write_b64 v247, v[224:225] offset:2048
    v_cvt_pk_bf16_f32 v228, v228, v229
    v_cvt_pk_bf16_f32 v229, v230, v231
    ds_write_b64 v248, v[228:229] offset:2048
    v_cvt_pk_bf16_f32 v232, v232, v233
    v_cvt_pk_bf16_f32 v233, v234, v235
    ds_write_b64 v249, v[232:233] offset:2048
    ds_read_b128 v[172:175], v250 offset:0
    ds_read_b128 v[176:179], v250 offset:1024
    ds_read_b128 v[180:183], v250 offset:2048
    ds_read_b128 v[184:187], v250 offset:3072
    s_cmp_lt_u32 s22, 4
    s_cbranch_scc1 K3_ST
    s_waitcnt lgkmcnt(0)
    s_barrier
    s_barrier
K3_ST:
    s_add_u32 s25, s72, 0
    s_waitcnt lgkmcnt(3)
    buffer_store_dwordx4 v[172:175], v251, s[8:11], s25 offen sc1
    s_add_u32 s25, s72, 32768
    s_waitcnt lgkmcnt(2)
    buffer_store_dwordx4 v[176:179], v251, s[8:11], s25 offen sc1
    s_add_u32 s25, s72, 65536
    s_waitcnt lgkmcnt(1)
    buffer_store_dwordx4 v[180:183], v251, s[8:11], s25 offen sc1
    s_add_u32 s25, s72, 98304
    s_waitcnt lgkmcnt(0)
    buffer_store_dwordx4 v[184:187], v251, s[8:11], s25 offen sc1
K_END:
    s_endpgm
K2_SLOW:
    v_mov_b32 v8, 0xff800000
    s_mov_b32 s33, 16842752
    s_mov_b32 s35, 0
    s_waitcnt lgkmcnt(0)
K2_SLOW10:
    buffer_load_dwordx4 v[28:31], v1, s[16:19], s33 offen sc1
    buffer_load_dwordx4 v[32:35], v1, s[16:19], s33 offen offset:1024 sc1
    s_waitcnt vmcnt(0)
    v_mfma_f32_32x32x16_bf16 v[64:79], v[28:31], v[16:19], 0
    v_mfma_f32_32x32x16_bf16 v[64:79], v[32:35], v[20:23], v[64:79]
    s_nop 15
    v_max3_f32 v8, v8, v64, v65
    v_max3_f32 v8, v8, v66, v67
    v_max3_f32 v8, v8, v68, v69
    v_max3_f32 v8, v8, v70, v71
    v_max3_f32 v8, v8, v72, v73
    v_max3_f32 v8, v8, v74, v75
    v_max3_f32 v8, v8, v76, v77
    v_max3_f32 v8, v8, v78, v79
    s_add_u32 s33, s33, 4096
    s_add_u32 s35, s35, 1
    s_cmp_lt_u32 s35, 64
    s_cbranch_scc1 K2_SLOW10
    v_mov_b32 v9, v8
    s_nop 1
    v_permlane32_swap_b32 v8, v9
    v_max_f32 v8, v8, v9
    v_sub_f32 v112, 0, v8
    v_mov_b32 v96, 0
    v_sub_f32 v113, 0, v8
    v_mov_b32 v97, 0
    v_sub_f32 v114, 0, v8
    v_mov_b32 v98, 0
    v_sub_f32 v115, 0, v8
    v_mov_b32 v99, 0
    v_sub_f32 v116, 0, v8
    v_mov_b32 v100, 0
    v_sub_f32 v117, 0, v8
    v_mov_b32 v101, 0
    v_sub_f32 v118, 0, v8
    v_mov_b32 v102, 0
    v_sub_f32 v119, 0, v8
    v_mov_b32 v103, 0
    v_sub_f32 v120, 0, v8
    v_mov_b32 v104, 0
    v_sub_f32 v121, 0, v8
    v_mov_b32 v105, 0
    v_sub_f32 v122, 0, v8
    v_mov_b32 v106, 0
    v_sub_f32 v123, 0, v8
    v_mov_b32 v107, 0
    v_sub_f32 v124, 0, v8
    v_mov_b32 v108, 0
    v_sub_f32 v125, 0, v8
    v_mov_b32 v109, 0
    v_sub_f32 v126, 0, v8
    v_mov_b32 v110, 0
    v_sub_f32 v127, 0, v8
    v_mov_b32 v111, 0
    v_mov_b32 v52, 0
    v_mov_b32 v53, 0
    v_mov_b32 v54, 0
    v_mov_b32 v55, 0
    s_mov_b32 s33, 16842752
    s_mov_b32 s35, 0
K2_SLOW20:
    buffer_load_dwordx4 v[28:31], v1, s[16:19], s33 offen offset:0 sc1
    buffer_load_dwordx4 v[36:39], v1, s[16:19], s33 offen offset:2048 sc1
    buffer_load_dwordx4 v[32:35], v1, s[16:19], s33 offen offset:1024 sc1
    buffer_load_dwordx4 v[40:43], v1, s[16:19], s33 offen offset:3072 sc1
    s_waitcnt vmcnt(0)
    v_mfma_f32_32x32x16_bf16 v[64:79], v[28:31], v[16:19], v[112:127]
    v_mfma_f32_32x32x16_bf16 v[64:79], v[32:35], v[20:23], v[64:79]
    s_nop 15
    v_exp_f32 v64, v64
    v_exp_f32 v65, v65
    v_exp_f32 v66, v66
    v_exp_f32 v67, v67
    v_exp_f32 v68, v68
    v_exp_f32 v69, v69
    v_exp_f32 v70, v70
    v_exp_f32 v71, v71
    v_exp_f32 v72, v72
    v_exp_f32 v73, v73
    v_exp_f32 v74, v74
    v_exp_f32 v75, v75
    v_exp_f32 v76, v76
    v_exp_f32 v77, v77
    v_exp_f32 v78, v78
    v_exp_f32 v79, v79
    s_nop 0
    v_cvt_pk_bf16_f32 v44, v64, v65
    v_cvt_pk_bf16_f32 v45, v66, v67
    v_cvt_pk_bf16_f32 v46, v68, v69
    v_cvt_pk_bf16_f32 v47, v70, v71
    v_cvt_pk_bf16_f32 v48, v72, v73
    v_cvt_pk_bf16_f32 v49, v74, v75
    v_cvt_pk_bf16_f32 v50, v76, v77
    v_cvt_pk_bf16_f32 v51, v78, v79
    s_nop 1
    v_mfma_f32_32x32x16_bf16 v[96:111], v[36:39], v[44:47], v[96:111]
    v_smfmac_f32_16x16x64_bf16 v[52:55], v[24:27], v[44:51], v62
    v_mfma_f32_32x32x16_bf16 v[96:111], v[40:43], v[48:51], v[96:111]
    s_nop 15
    s_add_u32 s33, s33, 4096
    s_add_u32 s35, s35, 1
    s_cmp_lt_u32 s35, 64
    s_cbranch_scc1 K2_SLOW20
    v_add_f32 v52, v52, v53
    v_mov_b32 v8, 0xff800000
    s_mov_b32 s33, 16842752
    s_mov_b32 s35, 0
    s_waitcnt lgkmcnt(0)
K2_SLOW11:
    buffer_load_dwordx4 v[28:31], v1, s[16:19], s33 offen sc1
    buffer_load_dwordx4 v[32:35], v1, s[16:19], s33 offen offset:1024 sc1
    s_waitcnt vmcnt(0)
    v_mfma_f32_32x32x16_bf16 v[64:79], v[28:31], v[128:131], 0
    v_mfma_f32_32x32x16_bf16 v[64:79], v[32:35], v[132:135], v[64:79]
    s_nop 15
    v_max3_f32 v8, v8, v64, v65
    v_max3_f32 v8, v8, v66, v67
    v_max3_f32 v8, v8, v68, v69
    v_max3_f32 v8, v8, v70, v71
    v_max3_f32 v8, v8, v72, v73
    v_max3_f32 v8, v8, v74, v75
    v_max3_f32 v8, v8, v76, v77
    v_max3_f32 v8, v8, v78, v79
    s_add_u32 s33, s33, 4096
    s_add_u32 s35, s35, 1
    s_cmp_lt_u32 s35, 64
    s_cbranch_scc1 K2_SLOW11
    v_mov_b32 v9, v8
    s_nop 1
    v_permlane32_swap_b32 v8, v9
    v_max_f32 v8, v8, v9
    v_sub_f32 v112, 0, v8
    v_mov_b32 v140, 0
    v_sub_f32 v113, 0, v8
    v_mov_b32 v141, 0
    v_sub_f32 v114, 0, v8
    v_mov_b32 v142, 0
    v_sub_f32 v115, 0, v8
    v_mov_b32 v143, 0
    v_sub_f32 v116, 0, v8
    v_mov_b32 v144, 0
    v_sub_f32 v117, 0, v8
    v_mov_b32 v145, 0
    v_sub_f32 v118, 0, v8
    v_mov_b32 v146, 0
    v_sub_f32 v119, 0, v8
    v_mov_b32 v147, 0
    v_sub_f32 v120, 0, v8
    v_mov_b32 v148, 0
    v_sub_f32 v121, 0, v8
    v_mov_b32 v149, 0
    v_sub_f32 v122, 0, v8
    v_mov_b32 v150, 0
    v_sub_f32 v123, 0, v8
    v_mov_b32 v151, 0
    v_sub_f32 v124, 0, v8
    v_mov_b32 v152, 0
    v_sub_f32 v125, 0, v8
    v_mov_b32 v153, 0
    v_sub_f32 v126, 0, v8
    v_mov_b32 v154, 0
    v_sub_f32 v127, 0, v8
    v_mov_b32 v155, 0
    v_mov_b32 v56, 0
    v_mov_b32 v57, 0
    v_mov_b32 v58, 0
    v_mov_b32 v59, 0
    s_mov_b32 s33, 16842752
    s_mov_b32 s35, 0
K2_SLOW21:
    buffer_load_dwordx4 v[28:31], v1, s[16:19], s33 offen offset:0 sc1
    buffer_load_dwordx4 v[36:39], v1, s[16:19], s33 offen offset:2048 sc1
    buffer_load_dwordx4 v[32:35], v1, s[16:19], s33 offen offset:1024 sc1
    buffer_load_dwordx4 v[40:43], v1, s[16:19], s33 offen offset:3072 sc1
    s_waitcnt vmcnt(0)
    v_mfma_f32_32x32x16_bf16 v[64:79], v[28:31], v[128:131], v[112:127]
    v_mfma_f32_32x32x16_bf16 v[64:79], v[32:35], v[132:135], v[64:79]
    s_nop 15
    v_exp_f32 v64, v64
    v_exp_f32 v65, v65
    v_exp_f32 v66, v66
    v_exp_f32 v67, v67
    v_exp_f32 v68, v68
    v_exp_f32 v69, v69
    v_exp_f32 v70, v70
    v_exp_f32 v71, v71
    v_exp_f32 v72, v72
    v_exp_f32 v73, v73
    v_exp_f32 v74, v74
    v_exp_f32 v75, v75
    v_exp_f32 v76, v76
    v_exp_f32 v77, v77
    v_exp_f32 v78, v78
    v_exp_f32 v79, v79
    s_nop 0
    v_cvt_pk_bf16_f32 v44, v64, v65
    v_cvt_pk_bf16_f32 v45, v66, v67
    v_cvt_pk_bf16_f32 v46, v68, v69
    v_cvt_pk_bf16_f32 v47, v70, v71
    v_cvt_pk_bf16_f32 v48, v72, v73
    v_cvt_pk_bf16_f32 v49, v74, v75
    v_cvt_pk_bf16_f32 v50, v76, v77
    v_cvt_pk_bf16_f32 v51, v78, v79
    s_nop 1
    v_mfma_f32_32x32x16_bf16 v[140:155], v[36:39], v[44:47], v[140:155]
    v_smfmac_f32_16x16x64_bf16 v[56:59], v[24:27], v[44:51], v62
    v_mfma_f32_32x32x16_bf16 v[140:155], v[40:43], v[48:51], v[140:155]
    s_nop 15
    s_add_u32 s33, s33, 4096
    s_add_u32 s35, s35, 1
    s_cmp_lt_u32 s35, 64
    s_cbranch_scc1 K2_SLOW21
    s_branch K2_FIN

.section .rodata,"a"
.p2align 6
.amdhsa_kernel concat_heads__linear_attn_block__grouped_kv_mqa__prompt_kernel
  .amdhsa_next_free_vgpr 256
  .amdhsa_next_free_sgpr 102
  .amdhsa_accum_offset 256
  .amdhsa_group_segment_fixed_size 0
  .amdhsa_kernarg_size 88
  .amdhsa_user_sgpr_count 2
  .amdhsa_user_sgpr_kernarg_segment_ptr 1
  .amdhsa_system_sgpr_workgroup_id_x 1
.end_amdhsa_kernel
```
